```python
import torch

def _softmax(x, axis=-1):
    return torch.softmax(x, dim=axis)
def _gelu(x):
    return torch.nn.functional.gelu(x, approximate="tanh")
def _silu(x):
    return torch.nn.functional.silu(x)
def _sigmoid(x):
    return torch.sigmoid(x)
def _layernorm(x, axis=-1, eps=1e-5):
    m = x.mean(dim=axis, keepdim=True)
    v = x.var(dim=axis, keepdim=True, unbiased=False)
    return (x - m) / torch.sqrt(v + eps)
def _scatter_add(tgt, idx, src, axis=0):
    return tgt.clone().index_add_(axis, idx, src)
def _segment_sum(src, seg, n):
    out = torch.zeros((n,) + src.shape[1:], dtype=src.dtype)
    return out.index_add_(0, seg, src)
def _pad(x, pw):
    flat = tuple(v for pair in reversed(pw) for v in pair)
    return torch.nn.functional.pad(x, flat)

kernel_name = 'sequential_preLN__spectral_gfnet__dense_activation_silu__prompt'

def setup_inputs():

    _w = (lambda a: (lambda t: t.to(torch.bfloat16) if t.is_floating_point() else t)(torch.as_tensor(a)))
    def _A_setup():
        B, S, D = 1, 2048, 512
        Df = D // 2 + 1
        return {
            "x": _w((lambda *s: torch.randn(*s, dtype=torch.bfloat16) * 0.05)(B, S, D)),
            "w_r": _w((lambda *s: torch.randn(*s, dtype=torch.bfloat16) * 0.4)(S, Df) * 0.02),
            "w_i": _w((lambda *s: torch.randn(*s, dtype=torch.bfloat16) * 0.4)(S, Df) * 0.02),
        }
    _A_in = _A_setup()

    def _B_setup():
        B, S, D, F = 1, 2048, 512, 1792
        return {
            "x": _w((lambda *s: torch.randn(*s, dtype=torch.bfloat16) * 0.05)(B, S, D)),
            "w1": _w((lambda *s: torch.randn(*s, dtype=torch.bfloat16) * 0.8)(D, F) * (D ** -0.5)),
            "w2": _w((lambda *s: torch.randn(*s, dtype=torch.bfloat16) * 0.1)(F, D) * (F ** -0.5)),
        }
    _B_in = _B_setup()

    return {
        "A_x": _A_in["x"],
        "A_w_r": _A_in["w_r"],
        "A_w_i": _A_in["w_i"],
        "B_x": _B_in["x"],
        "B_w1": _B_in["w1"],
        "B_w2": _B_in["w2"],
    }

def reference(A_x, A_w_r, A_w_i, B_x, B_w1, B_w2):
    def _A_ref(x, w_r, w_i):
        B, S, D = x.shape
        X = (lambda x, axes=(-2,-1): torch.fft.rfft2(x.float(), dim=axes))(x, axes=(-2, -1))
        W = w_r + 1j * w_i
        X = X * W
        y = (lambda x, s, axes=(-2,-1): torch.fft.irfft2(x, s=s, dim=axes).to(torch.bfloat16))(X, (S, D), axes=(-2, -1))
        return y

    def _B_ref(x, w1, w2):
        h = torch.einsum("bsd,df->bsf", x, w1)
        h = _silu(h)
        out = torch.einsum("bsf,fd->bsd", h, w2)
        return out

    x = A_x
    h = x + _A_ref(_layernorm(x, axis=-1), A_w_r, A_w_i)
    h2 = h + _B_ref(_layernorm(h, axis=-1), B_w1, B_w2)
    return h2
```

```asm
; @launch kernel=ka_kernel grid=(256,1,1) block=(1024,1,1) lds=34048
; @launch kernel=kb_kernel grid=(497,1,1) block=(256,1,1) lds=28672
; @launch kernel=kf_kernel grid=(256,1,1) block=(512,1,1) lds=163840
.amdgcn_target "amdgcn-amd-amdhsa--gfx950"
.text
.globl ka_kernel
.p2align 8
.type ka_kernel,@function
ka_kernel:
    s_load_dwordx4 s[4:7], s[0:1], 0
    s_load_dwordx2 s[8:9], s[0:1], 16
    s_load_dwordx4 s[12:15], s[0:1], 32
    s_load_dwordx2 s[10:11], s[0:1], 64
    s_cmp_ge_u32 s2, 256
    s_cbranch_scc1 LA_end
    v_and_b32 v1, 63, v0
    v_lshrrev_b32 v4, 6, v0
    v_and_b32 v2, 15, v0
    v_readfirstlane_b32 s40, v4
    v_lshrrev_b32 v3, 4, v1
    s_cmp_ge_u32 s2, 128
    s_cbranch_scc1 LA_other
    s_lshr_b32 s41, s2, 5
    s_and_b32 s42, s2, 31
    s_lshl_b32 s41, s41, 9
    s_lshl_b32 s43, s40, 5
    s_add_u32 s41, s41, s43
    s_add_u32 s41, s41, s42
    s_lshl_b32 s41, s41, 10
    v_lshlrev_b32 v5, 4, v1
    v_cvt_f32_u32 v40, v2
    v_lshlrev_b32 v41, 2, v3
    v_cvt_f32_u32 v41, v41
    v_mul_f32 v42, 0x3d000000, v40
    v_cmp_eq_u32 vcc, 0, v2
    v_mov_b32 v45, 0.5
    v_mov_b32 v46, 0x3e800000
    v_cndmask_b32 v43, v42, v45, vcc
    v_cndmask_b32 v44, v46, 0, vcc
    v_mul_f32 v45, v41, v42
    v_fma_f32 v46, v41, v43, v44
    v_fmamk_f32 v48, v42, 0x00000000, v45
    v_fmamk_f32 v49, v42, 0x3f800000, v45
    v_fmamk_f32 v50, v42, 0x40000000, v45
    v_fmamk_f32 v51, v42, 0x40400000, v45
    v_fmamk_f32 v52, v42, 0x41800000, v45
    v_fmamk_f32 v53, v42, 0x41880000, v45
    v_fmamk_f32 v54, v42, 0x41900000, v45
    v_fmamk_f32 v55, v42, 0x41980000, v45
    v_cos_f32 v48, v48
    v_cos_f32 v49, v49
    v_cos_f32 v50, v50
    v_cos_f32 v51, v51
    v_cos_f32 v52, v52
    v_cos_f32 v53, v53
    v_cos_f32 v54, v54
    v_cos_f32 v55, v55
    v_cvt_pk_f16_f32 v16, v48, v49
    v_cvt_pk_f16_f32 v17, v50, v51
    v_cvt_pk_f16_f32 v18, v52, v53
    v_cvt_pk_f16_f32 v19, v54, v55
    s_waitcnt lgkmcnt(0)
    s_mov_b32 s16, s4
    s_and_b32 s17, s5, 0xffff
    s_mov_b32 s18, 2097152
    s_mov_b32 s19, 0x20000
    buffer_load_dwordx4 v[8:11], v5, s[16:19], s41 offen
    s_mov_b32 s20, s10
    s_and_b32 s21, s11, 0xffff
    s_mov_b32 s22, 25165824
    s_mov_b32 s23, 0x20000
    v_fmamk_f32 v48, v43, 0x00000000, v46
    v_fmamk_f32 v49, v43, 0x3f800000, v46
    v_fmamk_f32 v50, v43, 0x40000000, v46
    v_fmamk_f32 v51, v43, 0x40400000, v46
    v_fmamk_f32 v52, v43, 0x41800000, v46
    v_fmamk_f32 v53, v43, 0x41880000, v46
    v_fmamk_f32 v54, v43, 0x41900000, v46
    v_fmamk_f32 v55, v43, 0x41980000, v46
    v_cos_f32 v48, v48
    v_cos_f32 v49, v49
    v_cos_f32 v50, v50
    v_cos_f32 v51, v51
    v_cos_f32 v52, v52
    v_cos_f32 v53, v53
    v_cos_f32 v54, v54
    v_cos_f32 v55, v55
    v_cvt_pk_f16_f32 v20, v48, v49
    v_cvt_pk_f16_f32 v21, v50, v51
    v_cvt_pk_f16_f32 v22, v52, v53
    v_cvt_pk_f16_f32 v23, v54, v55
    v_lshrrev_b32 v42, 1, v2
    v_lshlrev_b32 v42, 5, v42
    v_and_b32 v43, 1, v2
    v_cvt_f32_u32 v43, v43
    v_mul_f32 v43, 0x3e800000, v43
    s_sub_u32 s45, 32, s40
    s_cmp_eq_u32 s40, 0
    s_cselect_b32 s45, 16, s45
    v_add_u32 v44, s40, v42
    v_cvt_f32_u32 v44, v44
    v_mul_f32 v44, 0x3b000000, v44
    v_fma_f32 v46, v41, v44, v43
    v_add_u32 v45, s45, v42
    v_cvt_f32_u32 v45, v45
    v_mul_f32 v45, 0x3b000000, v45
    v_fma_f32 v47, v41, v45, v43
    v_fmamk_f32 v48, v44, 0x00000000, v46
    v_fmamk_f32 v49, v44, 0x3f800000, v46
    v_fmamk_f32 v50, v44, 0x40000000, v46
    v_fmamk_f32 v51, v44, 0x40400000, v46
    v_fmamk_f32 v52, v45, 0x00000000, v47
    v_fmamk_f32 v53, v45, 0x3f800000, v47
    v_fmamk_f32 v54, v45, 0x40000000, v47
    v_fmamk_f32 v55, v45, 0x40400000, v47
    s_cmp_eq_u32 s40, 0
    s_cbranch_scc1 LA_slot0
    v_sin_f32 v56, v48
    v_cos_f32 v48, v48
    v_sin_f32 v57, v49
    v_cos_f32 v49, v49
    v_sin_f32 v58, v50
    v_cos_f32 v50, v50
    v_sin_f32 v59, v51
    v_cos_f32 v51, v51
    v_sin_f32 v60, v52
    v_cos_f32 v52, v52
    v_sin_f32 v61, v53
    v_cos_f32 v53, v53
    v_sin_f32 v62, v54
    v_cos_f32 v54, v54
    v_sin_f32 v63, v55
    v_cos_f32 v55, v55
    v_cvt_pk_f16_f32 v24, v48, v56
    v_cvt_pk_f16_f32 v25, v49, v57
    v_cvt_pk_f16_f32 v26, v50, v58
    v_cvt_pk_f16_f32 v27, v51, v59
    v_cvt_pk_f16_f32 v28, v52, -v60
    v_cvt_pk_f16_f32 v29, v53, -v61
    v_cvt_pk_f16_f32 v30, v54, -v62
    v_cvt_pk_f16_f32 v31, v55, -v63
    s_branch LA_slot0_done
LA_slot0:
    v_cos_f32 v48, v48
    v_cos_f32 v49, v49
    v_cos_f32 v50, v50
    v_cos_f32 v51, v51
    v_cos_f32 v52, v52
    v_cos_f32 v53, v53
    v_cos_f32 v54, v54
    v_cos_f32 v55, v55
    v_cmp_eq_u32 vcc, 1, v2
    s_nop 1
    v_cndmask_b32 v48, v48, 1.0, vcc
    v_cndmask_b32 v49, v49, -1.0, vcc
    v_cndmask_b32 v50, v50, 1.0, vcc
    v_cndmask_b32 v51, v51, -1.0, vcc
    v_cvt_pk_f16_f32 v24, v48, 0
    v_cvt_pk_f16_f32 v25, v49, 0
    v_cvt_pk_f16_f32 v26, v50, 0
    v_cvt_pk_f16_f32 v27, v51, 0
    v_cvt_pk_f16_f32 v28, 0, v52
    v_cvt_pk_f16_f32 v29, 0, v53
    v_cvt_pk_f16_f32 v30, 0, v54
    v_cvt_pk_f16_f32 v31, 0, v55
LA_slot0_done:
    s_nop 4
    s_lshl_b32 s44, s40, 10
    v_add_u32 v32, s44, v5
    v_lshlrev_b32 v33, 3, v1
    v_add_u32 v33, s44, v33
    s_lshr_b32 s46, s40, 3
    s_lshl_b32 s46, s46, 1
    v_xor_b32 v34, s46, v3
    v_lshlrev_b32 v34, 4, v34
    v_mul_u32_u24 v40, 1040, v2
    v_add_u32 v34, v34, v40
    s_lshl_b32 s46, s40, 6
    v_add_u32 v34, s46, v34
    v_lshrrev_b32 v40, 3, v2
    v_lshlrev_b32 v40, 1, v40
    v_xor_b32 v40, v40, v3
    v_lshlrev_b32 v40, 4, v40
    v_lshl_add_u32 v35, v2, 6, v40
    s_mul_i32 s46, s40, 1040
    v_add_u32 v35, s46, v35
    s_mul_i32 s43, s2, 16640
    v_lshlrev_b32 v36, 7, v3
    v_lshl_add_u32 v36, v2, 2, v36
    v_add_u32 v36, s44, v36
    s_add_u32 s46, s43, s44
    s_waitcnt vmcnt(0)
    v_lshlrev_b32 v40, 16, v8
    v_and_b32 v41, 0xffff0000, v8
    v_lshlrev_b32 v42, 16, v9
    v_and_b32 v43, 0xffff0000, v9
    v_lshlrev_b32 v44, 16, v10
    v_and_b32 v45, 0xffff0000, v10
    v_lshlrev_b32 v46, 16, v11
    v_and_b32 v47, 0xffff0000, v11
    v_readfirstlane_b32 s48, v40
    s_nop 1
    v_pk_add_f32 v[56:57], v[40:41], s[48:49] op_sel_hi:[1,0] neg_lo:[0,1] neg_hi:[0,1]
    v_pk_add_f32 v[58:59], v[42:43], s[48:49] op_sel_hi:[1,0] neg_lo:[0,1] neg_hi:[0,1]
    v_pk_add_f32 v[60:61], v[44:45], s[48:49] op_sel_hi:[1,0] neg_lo:[0,1] neg_hi:[0,1]
    v_pk_add_f32 v[62:63], v[46:47], s[48:49] op_sel_hi:[1,0] neg_lo:[0,1] neg_hi:[0,1]
    v_pk_add_f32 v[48:49], v[56:57], v[58:59]
    v_pk_mul_f32 v[50:51], v[56:57], v[56:57]
    v_pk_add_f32 v[54:55], v[60:61], v[62:63]
    v_pk_fma_f32 v[50:51], v[58:59], v[58:59], v[50:51]
    v_pk_add_f32 v[48:49], v[48:49], v[54:55]
    v_pk_fma_f32 v[50:51], v[60:61], v[60:61], v[50:51]
    v_add_f32 v48, v48, v49
    v_pk_fma_f32 v[50:51], v[62:63], v[62:63], v[50:51]
    v_add_f32 v50, v50, v51
    v_add_f32_dpp v48, v48, v48 row_shr:1 row_mask:0xf bank_mask:0xf bound_ctrl:0
    s_nop 0
    v_add_f32_dpp v50, v50, v50 row_shr:1 row_mask:0xf bank_mask:0xf bound_ctrl:0
    v_add_f32_dpp v48, v48, v48 row_shr:2 row_mask:0xf bank_mask:0xf bound_ctrl:0
    s_nop 0
    v_add_f32_dpp v50, v50, v50 row_shr:2 row_mask:0xf bank_mask:0xf bound_ctrl:0
    v_add_f32_dpp v48, v48, v48 row_shr:4 row_mask:0xf bank_mask:0xf bound_ctrl:0
    s_nop 0
    v_add_f32_dpp v50, v50, v50 row_shr:4 row_mask:0xf bank_mask:0xf bound_ctrl:0
    v_add_f32_dpp v48, v48, v48 row_shr:8 row_mask:0xf bank_mask:0xf bound_ctrl:0
    s_nop 0
    v_add_f32_dpp v50, v50, v50 row_shr:8 row_mask:0xf bank_mask:0xf bound_ctrl:0
    v_add_f32_dpp v48, v48, v48 row_bcast:15 row_mask:0xa bank_mask:0xf
    s_nop 0
    v_add_f32_dpp v50, v50, v50 row_bcast:15 row_mask:0xa bank_mask:0xf
    v_add_f32_dpp v48, v48, v48 row_bcast:31 row_mask:0xc bank_mask:0xf
    s_nop 0
    v_add_f32_dpp v50, v50, v50 row_bcast:31 row_mask:0xc bank_mask:0xf
    v_readlane_b32 s50, v48, 63
    v_readlane_b32 s52, v50, 63
    v_mov_b32 v54, 0x3b000000
    v_mul_f32 v48, s50, v54
    v_mul_f32 v50, s52, v54
    v_add_f32 v52, s48, v48
    v_fma_f32 v50, -v48, v48, v50
    v_cvt_pk_bf16_f32 v52, v52, v52
    v_max_f32 v50, 0, v50
    v_lshlrev_b32 v52, 16, v52
    v_cvt_pk_bf16_f32 v50, v50, v50
    v_lshlrev_b32 v50, 16, v50
    v_pk_add_f32 v[56:57], v[40:41], v[52:53] op_sel_hi:[1,0] neg_lo:[0,1] neg_hi:[0,1]
    v_pk_add_f32 v[58:59], v[42:43], v[52:53] op_sel_hi:[1,0] neg_lo:[0,1] neg_hi:[0,1]
    v_add_f32 v50, 0x3727c5ac, v50
    v_pk_add_f32 v[60:61], v[44:45], v[52:53] op_sel_hi:[1,0] neg_lo:[0,1] neg_hi:[0,1]
    v_pk_add_f32 v[62:63], v[46:47], v[52:53] op_sel_hi:[1,0] neg_lo:[0,1] neg_hi:[0,1]
    v_cvt_pk_bf16_f32 v50, v50, v50
    v_cvt_pk_bf16_f32 v56, v56, v57
    v_cvt_pk_bf16_f32 v58, v58, v59
    v_lshlrev_b32 v50, 16, v50
    v_cvt_pk_bf16_f32 v60, v60, v61
    v_cvt_pk_bf16_f32 v62, v62, v63
    v_sqrt_f32 v50, v50
    v_and_b32 v57, 0xffff0000, v56
    v_lshlrev_b32 v56, 16, v56
    v_cvt_pk_bf16_f32 v50, v50, v50
    v_and_b32 v59, 0xffff0000, v58
    v_lshlrev_b32 v58, 16, v58
    v_lshlrev_b32 v50, 16, v50
    v_and_b32 v61, 0xffff0000, v60
    v_lshlrev_b32 v60, 16, v60
    v_rcp_f32 v50, v50
    v_and_b32 v63, 0xffff0000, v62
    v_lshlrev_b32 v62, 16, v62
    v_pk_mul_f32 v[56:57], v[56:57], v[50:51] op_sel_hi:[1,0]
    v_pk_mul_f32 v[58:59], v[58:59], v[50:51] op_sel_hi:[1,0]
    v_pk_mul_f32 v[60:61], v[60:61], v[50:51] op_sel_hi:[1,0]
    v_pk_mul_f32 v[62:63], v[62:63], v[50:51] op_sel_hi:[1,0]
    v_cvt_pk_bf16_f32 v56, v56, v57
    v_cvt_pk_bf16_f32 v58, v58, v59
    v_cvt_pk_bf16_f32 v60, v60, v61
    v_cvt_pk_bf16_f32 v62, v62, v63
    v_and_b32 v57, 0xffff0000, v56
    v_lshlrev_b32 v56, 16, v56
    v_and_b32 v59, 0xffff0000, v58
    v_lshlrev_b32 v58, 16, v58
    v_and_b32 v61, 0xffff0000, v60
    v_lshlrev_b32 v60, 16, v60
    v_and_b32 v63, 0xffff0000, v62
    v_lshlrev_b32 v62, 16, v62
    v_cvt_pk_f16_f32 v8, v56, v57
    v_cvt_pk_f16_f32 v9, v58, v59
    v_cvt_pk_f16_f32 v10, v60, v61
    v_cvt_pk_f16_f32 v11, v62, v63
    ds_write_b128 v32, v[8:11]
    s_waitcnt lgkmcnt(0)
    ds_read_b64_tr_b16 v[40:41], v33 offset:0
    ds_read_b64_tr_b16 v[42:43], v33 offset:512
    s_waitcnt lgkmcnt(0)
    v_mfma_f32_16x16x32_f16 v[48:51], v[40:43], v[16:19], 0
    v_mfma_f32_16x16x32_f16 v[52:55], v[40:43], v[20:23], 0
    s_nop 7
    v_cvt_pk_f16_f32 v8, v48, v52
    v_cvt_pk_f16_f32 v9, v49, v53
    v_cvt_pk_f16_f32 v10, v50, v54
    v_cvt_pk_f16_f32 v11, v51, v55
    ds_write_b128 v34, v[8:11] offset:16384
    s_waitcnt lgkmcnt(0)
    s_barrier
    ds_read_b128 v[40:43], v35 offset:16384
    s_waitcnt lgkmcnt(0)
    v_mfma_f32_16x16x32_f16 v[48:51], v[24:27], v[40:43], 0
    v_mfma_f32_16x16x32_f16 v[52:55], v[28:31], v[40:43], 0
    s_nop 6
    v_cvt_pk_f16_f32 v12, v48, v49
    ds_write_b32 v36, v12 offset:0
    v_cvt_pk_f16_f32 v13, v50, v51
    ds_write_b32 v36, v13 offset:64
    v_cvt_pk_f16_f32 v14, v52, v53
    ds_write_b32 v36, v14 offset:512
    v_cvt_pk_f16_f32 v15, v54, v55
    ds_write_b32 v36, v15 offset:576
    s_waitcnt lgkmcnt(0)
    ds_read_b128 v[8:11], v32
    s_waitcnt lgkmcnt(0)
    buffer_store_dwordx4 v[8:11], v5, s[20:23], s46 offen sc1
    s_endpgm
LA_other:
    s_waitcnt lgkmcnt(0)
    s_mov_b32 s20, s10
    s_and_b32 s21, s11, 0xffff
    s_mov_b32 s22, 25165824
    s_mov_b32 s23, 0x20000
    s_mov_b32 s24, s6
    s_and_b32 s25, s7, 0xffff
    s_mov_b32 s26, 1052672
    s_mov_b32 s27, 0x20000
    s_mov_b32 s28, s8
    s_and_b32 s29, s9, 0xffff
    s_mov_b32 s30, 1052672
    s_mov_b32 s31, 0x20000
    s_sub_u32 s41, s2, 128
    s_lshr_b32 s42, s41, 1
    s_and_b32 s43, s41, 1
    s_lshr_b32 s44, s40, 1
    s_lshr_b32 s45, s44, 1
    s_and_b32 s46, s44, 1
    s_lshl_b32 s45, s45, 8
    s_lshl_b32 s46, s46, 10
    s_add_u32 s45, s45, s46
    s_add_u32 s45, s45, s42
    s_mul_i32 s45, s45, 514
    s_and_b32 s46, s40, 1
    s_lshl_b32 s46, s46, 6
    s_lshl_b32 s47, s43, 7
    s_add_u32 s46, s46, s47
    v_add_u32 v5, s46, v1
    v_lshlrev_b32 v6, 1, v5
    buffer_load_ushort v8, v6, s[24:27], s45 offen
    buffer_load_ushort v12, v6, s[28:31], s45 offen
    s_add_u32 s49, s45, 32896
    buffer_load_ushort v9, v6, s[24:27], s49 offen
    buffer_load_ushort v13, v6, s[28:31], s49 offen
    s_add_u32 s50, s45, 65792
    buffer_load_ushort v10, v6, s[24:27], s50 offen
    buffer_load_ushort v14, v6, s[28:31], s50 offen
    s_add_u32 s51, s45, 98688
    buffer_load_ushort v11, v6, s[24:27], s51 offen
    buffer_load_ushort v15, v6, s[28:31], s51 offen
    s_cmp_eq_u32 s46, 192
    s_cselect_b32 s52, 4, 0
    v_cmp_gt_u32 vcc, s52, v1
    s_mov_b32 s53, 32896
    v_mul_lo_u32 v16, v1, s53
    v_add_u32 v16, 512, v16
    v_mov_b32 v18, 1073741824
    v_cndmask_b32 v16, v18, v16, vcc
    buffer_load_ushort v19, v16, s[24:27], s45 offen
    buffer_load_ushort v20, v16, s[28:31], s45 offen
    s_mul_i32 s47, s42, 33024
    s_lshl_b32 s53, s44, 4
    s_add_u32 s47, s47, s53
    s_add_u32 s47, s47, 2129920
    v_lshlrev_b32 v7, 7, v5
    v_lshlrev_b32 v17, 2, v1
    v_add_u32 v17, 32768, v17
    v_cndmask_b32 v17, v18, v17, vcc
    s_cmp_ge_u32 s2, 136
    s_cbranch_scc1 LA_nocpf
    s_getpc_b64 s[56:57]
LA_pc:
    s_add_u32 s56, s56, kb_kernel-LA_pc
    s_addc_u32 s57, s57, 0
    s_and_b32 s57, s57, 0xffff
    s_mov_b32 s58, LF_codeend-kb_kernel
    s_mov_b32 s59, 0x20000
    v_lshlrev_b32 v28, 5, v0
    buffer_load_dwordx4 v[32:35], v28, s[56:59], 0 offen
    s_waitcnt vmcnt(0)
    buffer_load_dwordx4 v[32:35], v28, s[56:59], 0 offen offset:16
LA_nocpf:
    s_cmp_ge_u32 s2, 130
    s_cbranch_scc1 LA_noz
    v_mov_b32 v24, 0
    v_mov_b32 v25, 0
    v_mov_b32 v26, 0
    v_mov_b32 v27, 0
    v_lshlrev_b32 v28, 4, v0
    s_sub_u32 s53, s2, 128
    s_lshl_b32 s53, s53, 14
    s_add_u32 s53, s53, 21610496
    buffer_store_dwordx4 v[24:27], v28, s[20:23], s53 offen sc1
LA_noz:
    s_waitcnt vmcnt(0)
    v_and_b32 v40, 0x7fff, v8
    v_and_b32 v41, 0x7fff, v9
    v_and_b32 v42, 0x7fff, v10
    v_and_b32 v43, 0x7fff, v11
    v_and_b32 v44, 0x7fff, v12
    v_and_b32 v45, 0x7fff, v13
    v_and_b32 v46, 0x7fff, v14
    v_and_b32 v47, 0x7fff, v15
    v_and_b32 v51, 0x7fff, v19
    v_and_b32 v52, 0x7fff, v20
    v_max3_u32 v23, v40, v41, v42
    v_max3_u32 v23, v23, v43, v44
    v_max3_u32 v23, v23, v45, v46
    v_max3_u32 v23, v23, v47, v51
    v_max_u32 v23, v23, v52
    s_nop 1
    v_max_u32_dpp v23, v23, v23 row_shr:1 row_mask:0xf bank_mask:0xf
    s_nop 1
    v_max_u32_dpp v23, v23, v23 row_shr:2 row_mask:0xf bank_mask:0xf
    s_nop 1
    v_max_u32_dpp v23, v23, v23 row_shr:4 row_mask:0xf bank_mask:0xf
    s_nop 1
    v_max_u32_dpp v23, v23, v23 row_shr:8 row_mask:0xf bank_mask:0xf
    s_nop 1
    v_max_u32_dpp v23, v23, v23 row_bcast:15 row_mask:0xa bank_mask:0xf
    s_nop 1
    v_max_u32_dpp v23, v23, v23 row_bcast:31 row_mask:0xc bank_mask:0xf
    s_nop 0
    v_readlane_b32 s50, v23, 63
    s_lshl_b32 s51, s40, 2
    s_add_u32 s51, s51, 16384
    v_mov_b32 v40, s51
    v_mov_b32 v41, s50
    ds_write_b32 v40, v41
    v_lshl_or_b32 v8, v12, 16, v8
    v_lshl_or_b32 v9, v13, 16, v9
    v_lshl_or_b32 v10, v14, 16, v10
    v_lshl_or_b32 v11, v15, 16, v11
    v_and_b32 v21, 127, v5
    v_and_b32 v22, 7, v5
    v_xor_b32 v22, s44, v22
    v_lshlrev_b32 v22, 4, v22
    v_lshl_add_u32 v21, v21, 7, v22
    ds_write_b128 v21, v[8:11]
    s_nop 1
    v_lshrrev_b32 v21, 3, v0
    v_xor_b32 v22, v21, v0
    v_and_b32 v22, 7, v22
    v_lshlrev_b32 v22, 4, v22
    v_lshl_add_u32 v21, v21, 7, v22
    v_lshlrev_b32 v7, 4, v0
    s_mul_i32 s48, s42, 33024
    s_lshl_b32 s49, s43, 14
    s_add_u32 s48, s48, s49
    s_add_u32 s48, s48, 2129920
    s_waitcnt lgkmcnt(0)
    s_barrier
    ds_read_b128 v[8:11], v21
    v_lshlrev_b32 v40, 2, v2
    ds_read_b32 v23, v40 offset:16384
    s_waitcnt lgkmcnt(1)
    buffer_store_dwordx4 v[8:11], v7, s[20:23], s48 offen sc1
    s_waitcnt lgkmcnt(0)
    v_max_u32_dpp v23, v23, v23 row_shr:1 row_mask:0xf bank_mask:0xf
    s_nop 1
    v_max_u32_dpp v23, v23, v23 row_shr:2 row_mask:0xf bank_mask:0xf
    s_nop 1
    v_max_u32_dpp v23, v23, v23 row_shr:4 row_mask:0xf bank_mask:0xf
    s_nop 1
    v_max_u32_dpp v23, v23, v23 row_shr:8 row_mask:0xf bank_mask:0xf
    s_nop 1
    v_max_u32_dpp v23, v23, v23 row_bcast:15 row_mask:0xa bank_mask:0xf
    s_nop 1
    v_max_u32_dpp v23, v23, v23 row_bcast:31 row_mask:0xc bank_mask:0xf
    s_lshl_b32 s50, s41, 2
    s_add_u32 s50, s50, 21643264
    v_cmp_eq_u32 vcc, 63, v0
    v_mov_b32 v40, 1073741824
    s_nop 0
    v_cndmask_b32 v40, v40, 0, vcc
    buffer_store_dword v23, v40, s[20:23], s50 offen sc1
    v_lshl_or_b32 v19, v20, 16, v19
    buffer_store_dword v19, v17, s[20:23], s47 offen sc1
    s_endpgm
LA_end:
    s_nop 2
    s_endpgm

.section .rodata,"a"
.p2align 6
.amdhsa_kernel ka_kernel
  .amdhsa_next_free_vgpr 64
  .amdhsa_next_free_sgpr 60
  .amdhsa_accum_offset 64
  .amdhsa_group_segment_fixed_size 0
  .amdhsa_kernarg_size 72
  .amdhsa_user_sgpr_count 2
  .amdhsa_user_sgpr_kernarg_segment_ptr 1
  .amdhsa_system_sgpr_workgroup_id_x 1
.end_amdhsa_kernel
.text
.globl kb_kernel
.p2align 8
.type kb_kernel,@function
kb_kernel:
    s_load_dwordx2 s[10:11], s[0:1], 64
    s_load_dwordx4 s[12:15], s[0:1], 32
    s_cmp_ge_u32 s2, 497
    s_cbranch_scc1 LB_end
    v_and_b32 v1, 63, v0
    v_lshrrev_b32 v4, 6, v0
    v_and_b32 v2, 15, v0
    v_readfirstlane_b32 s40, v4
    v_lshrrev_b32 v3, 4, v1
    s_cmp_ge_u32 s2, 257
    s_cbranch_scc1 LB_pack
    s_and_b32 s41, s2, 0x1f0
    s_and_b32 s42, s2, 7
    s_lshl_b32 s42, s42, 1
    s_add_u32 s41, s41, s42
    s_lshr_b32 s42, s2, 3
    s_and_b32 s42, s42, 1
    s_add_u32 s41, s41, s42
    s_and_b32 s42, s41, 255
    s_lshl_b32 s43, s42, 6
    s_lshr_b32 s44, s42, 4
    s_sub_u32 s45, 32, s44
    s_cmp_eq_u32 s44, 0
    s_cselect_b32 s45, 16, s45
    s_bitcmp1_b32 s42, 3
    s_cselect_b32 s44, s45, s44
    s_and_b32 s45, s42, 7
    s_lshl_b32 s45, s45, 5
    s_add_u32 s42, s44, s45
    s_cmp_eq_u32 s41, 256
    s_cselect_b32 s41, 256, s42
    s_mul_i32 s44, s40, 532480
    s_add_u32 s43, s43, s44
    s_add_u32 s44, s43, 266240
    v_lshrrev_b32 v5, 2, v1
    v_mul_u32_u24 v5, 16640, v5
    v_lshrrev_b32 v6, 5, v1
    v_lshlrev_b32 v6, 1, v6
    v_and_b32 v7, 3, v1
    v_xor_b32 v6, v6, v7
    v_lshl_add_u32 v5, v6, 4, v5
    v_lshrrev_b32 v6, 3, v1
    v_and_b32 v7, 7, v1
    v_xor_b32 v7, v7, v6
    v_mul_u32_u24 v6, 33024, v6
    v_lshl_add_u32 v6, v7, 4, v6
    s_mul_i32 s45, s40, 528384
    s_lshl_b32 s46, s41, 7
    s_add_u32 s45, s45, s46
    s_add_u32 s45, s45, 2129920
    s_add_u32 s47, s45, 264192
    s_lshl_b32 s46, s40, 11
    s_lshl_b32 s48, s40, 4
    v_add_u32 v232, s48, v2
    v_cvt_f32_u32 v232, v232
    v_lshlrev_b32 v233, 2, v3
    v_cvt_f32_u32 v233, v233
    v_mul_f32 v234, 0x3c800000, v232
    v_mul_f32 v235, v233, v234
    s_waitcnt lgkmcnt(0)
    s_mov_b32 s20, s10
    s_and_b32 s21, s11, 0xffff
    s_mov_b32 s22, 25165824
    s_mov_b32 s23, 0x20000
    s_mov_b32 m0, s46
    s_nop 0
    buffer_load_dwordx4 v5, s[20:23], s43 offen lds
    s_add_u32 m0, s46, 1024
    s_nop 0
    buffer_load_dwordx4 v5, s[20:23], s44 offen lds
    s_add_u32 m0, s46, 8192
    s_nop 0
    buffer_load_dwordx4 v6, s[20:23], s45 offen lds
    s_add_u32 m0, s46, 9216
    s_nop 0
    buffer_load_dwordx4 v6, s[20:23], s47 offen lds
    v_lshlrev_b32 v7, 3, v1
    s_mov_b32 s52, 21643264
    buffer_load_dwordx2 v[48:49], v7, s[20:23], s52 offen
    v_fmamk_f32 v144, v234, 0x00000000, v235
    v_fmamk_f32 v145, v234, 0x3f800000, v235
    v_fmamk_f32 v146, v234, 0x40000000, v235
    v_fmamk_f32 v147, v234, 0x40400000, v235
    v_fmamk_f32 v148, v234, 0x41800000, v235
    v_fmamk_f32 v149, v234, 0x41880000, v235
    v_fmamk_f32 v150, v234, 0x41900000, v235
    v_fmamk_f32 v151, v234, 0x41980000, v235
    v_sin_f32 v152, v144
    v_cos_f32 v144, v144
    v_sin_f32 v153, v145
    v_cos_f32 v145, v145
    v_sin_f32 v154, v146
    v_cos_f32 v146, v146
    v_sin_f32 v155, v147
    v_cos_f32 v147, v147
    v_sin_f32 v156, v148
    v_cos_f32 v148, v148
    v_sin_f32 v157, v149
    v_cos_f32 v149, v149
    v_sin_f32 v158, v150
    v_cos_f32 v150, v150
    v_sin_f32 v159, v151
    v_cos_f32 v151, v151
    v_cvt_pk_f16_f32 v16, v144, v152
    v_cvt_pk_f16_f32 v32, -v152, v144
    v_cvt_pk_f16_f32 v17, v145, v153
    v_cvt_pk_f16_f32 v33, -v153, v145
    v_cvt_pk_f16_f32 v18, v146, v154
    v_cvt_pk_f16_f32 v34, -v154, v146
    v_cvt_pk_f16_f32 v19, v147, v155
    v_cvt_pk_f16_f32 v35, -v155, v147
    v_cvt_pk_f16_f32 v20, v148, v156
    v_cvt_pk_f16_f32 v36, -v156, v148
    v_cvt_pk_f16_f32 v21, v149, v157
    v_cvt_pk_f16_f32 v37, -v157, v149
    v_cvt_pk_f16_f32 v22, v150, v158
    v_cvt_pk_f16_f32 v38, -v158, v150
    v_cvt_pk_f16_f32 v23, v151, v159
    v_cvt_pk_f16_f32 v39, -v159, v151
    v_fmamk_f32 v144, v234, 0x42000000, v235
    v_fmamk_f32 v145, v234, 0x42040000, v235
    v_fmamk_f32 v146, v234, 0x42080000, v235
    v_fmamk_f32 v147, v234, 0x420c0000, v235
    v_fmamk_f32 v148, v234, 0x42400000, v235
    v_fmamk_f32 v149, v234, 0x42440000, v235
    v_fmamk_f32 v150, v234, 0x42480000, v235
    v_fmamk_f32 v151, v234, 0x424c0000, v235
    v_sin_f32 v152, v144
    v_cos_f32 v144, v144
    v_sin_f32 v153, v145
    v_cos_f32 v145, v145
    v_sin_f32 v154, v146
    v_cos_f32 v146, v146
    v_sin_f32 v155, v147
    v_cos_f32 v147, v147
    v_sin_f32 v156, v148
    v_cos_f32 v148, v148
    v_sin_f32 v157, v149
    v_cos_f32 v149, v149
    v_sin_f32 v158, v150
    v_cos_f32 v150, v150
    v_sin_f32 v159, v151
    v_cos_f32 v151, v151
    v_cvt_pk_f16_f32 v24, v144, v152
    v_cvt_pk_f16_f32 v40, -v152, v144
    v_cvt_pk_f16_f32 v25, v145, v153
    v_cvt_pk_f16_f32 v41, -v153, v145
    v_cvt_pk_f16_f32 v26, v146, v154
    v_cvt_pk_f16_f32 v42, -v154, v146
    v_cvt_pk_f16_f32 v27, v147, v155
    v_cvt_pk_f16_f32 v43, -v155, v147
    v_cvt_pk_f16_f32 v28, v148, v156
    v_cvt_pk_f16_f32 v44, -v156, v148
    v_cvt_pk_f16_f32 v29, v149, v157
    v_cvt_pk_f16_f32 v45, -v157, v149
    v_cvt_pk_f16_f32 v30, v150, v158
    v_cvt_pk_f16_f32 v46, -v158, v150
    v_cvt_pk_f16_f32 v31, v151, v159
    v_cvt_pk_f16_f32 v47, -v159, v151
    v_mul_f32 v234, 0x3a000000, v232
    v_mul_f32 v235, v233, v234
    v_fmamk_f32 v144, v234, 0x00000000, v235
    v_fmamk_f32 v145, v234, 0x3f800000, v235
    v_fmamk_f32 v146, v234, 0x40000000, v235
    v_fmamk_f32 v147, v234, 0x40400000, v235
    v_fmamk_f32 v148, v234, 0x41800000, v235
    v_fmamk_f32 v149, v234, 0x41880000, v235
    v_fmamk_f32 v150, v234, 0x41900000, v235
    v_fmamk_f32 v151, v234, 0x41980000, v235
    v_cos_f32 v128, v144
    v_sin_f32 v136, v144
    v_cos_f32 v129, v145
    v_sin_f32 v137, v145
    v_cos_f32 v130, v146
    v_sin_f32 v138, v146
    v_cos_f32 v131, v147
    v_sin_f32 v139, v147
    v_cos_f32 v132, v148
    v_sin_f32 v140, v148
    v_cos_f32 v133, v149
    v_sin_f32 v141, v149
    v_cos_f32 v134, v150
    v_sin_f32 v142, v150
    v_cos_f32 v135, v151
    v_sin_f32 v143, v151
    s_mov_b32 s50, 0x3b800000
    v_pk_mul_f32 v[128:129], v[128:129], s[50:51] op_sel_hi:[1,0]
    v_pk_mul_f32 v[136:137], v[136:137], s[50:51] op_sel_hi:[1,0]
    v_pk_mul_f32 v[130:131], v[130:131], s[50:51] op_sel_hi:[1,0]
    v_pk_mul_f32 v[138:139], v[138:139], s[50:51] op_sel_hi:[1,0]
    v_pk_mul_f32 v[132:133], v[132:133], s[50:51] op_sel_hi:[1,0]
    v_pk_mul_f32 v[140:141], v[140:141], s[50:51] op_sel_hi:[1,0]
    v_pk_mul_f32 v[134:135], v[134:135], s[50:51] op_sel_hi:[1,0]
    v_pk_mul_f32 v[142:143], v[142:143], s[50:51] op_sel_hi:[1,0]
    v_lshrrev_b32 v236, 3, v2
    v_lshlrev_b32 v236, 1, v236
    v_xor_b32 v236, v236, v3
    v_lshlrev_b32 v236, 4, v236
    v_lshl_add_u32 v4, v2, 6, v236
    v_mul_u32_u24 v5, 1088, v3
    v_lshl_add_u32 v5, v2, 2, v5
    s_lshl_b32 s47, s40, 6
    v_add_u32 v5, s47, v5
    v_mul_u32_u24 v6, 272, v2
    v_lshl_add_u32 v6, v3, 4, v6
    v_lshlrev_b32 v7, 8, v2
    v_lshl_add_u32 v7, v3, 4, v7
    v_lshlrev_b32 v236, 1, v3
    v_and_b32 v237, 7, v2
    v_xor_b32 v236, v236, v237
    v_lshlrev_b32 v238, 7, v2
    v_add_u32 v238, s46, v238
    v_xor_b32 v237, 1, v236
    v_lshl_add_u32 v239, v237, 4, v238
    v_lshl_add_u32 v238, v236, 4, v238
    s_mul_i32 s48, s42, 8448
    s_add_u32 s48, s48, s47
    s_add_u32 s48, s48, 4243456
    s_add_u32 s49, s48, 4096
    v_cvt_f32_u32 v232, v2
    v_mul_f32 v234, 0x3d000000, v232
    v_mul_f32 v235, v233, v234
    v_fmamk_f32 v176, v234, 0x00000000, v235
    v_fmamk_f32 v177, v234, 0x3f800000, v235
    v_fmamk_f32 v178, v234, 0x40000000, v235
    v_fmamk_f32 v179, v234, 0x40400000, v235
    v_fmamk_f32 v180, v234, 0x41800000, v235
    v_fmamk_f32 v181, v234, 0x41880000, v235
    v_fmamk_f32 v182, v234, 0x41900000, v235
    v_fmamk_f32 v183, v234, 0x41980000, v235
    v_sin_f32 v184, v176
    v_cos_f32 v176, v176
    v_sin_f32 v185, v177
    v_cos_f32 v177, v177
    v_sin_f32 v186, v178
    v_cos_f32 v178, v178
    v_sin_f32 v187, v179
    v_cos_f32 v179, v179
    v_sin_f32 v188, v180
    v_cos_f32 v180, v180
    v_sin_f32 v189, v181
    v_cos_f32 v181, v181
    v_sin_f32 v190, v182
    v_cos_f32 v182, v182
    v_sin_f32 v191, v183
    v_cos_f32 v183, v183
    v_cvt_pk_f16_f32 v80, v176, v177
    v_cvt_pk_f16_f32 v88, v184, v185
    v_cvt_pk_f16_f32 v96, -v184, -v185
    v_cvt_pk_f16_f32 v81, v178, v179
    v_cvt_pk_f16_f32 v89, v186, v187
    v_cvt_pk_f16_f32 v97, -v186, -v187
    v_cvt_pk_f16_f32 v82, v180, v181
    v_cvt_pk_f16_f32 v90, v188, v189
    v_cvt_pk_f16_f32 v98, -v188, -v189
    v_cvt_pk_f16_f32 v83, v182, v183
    v_cvt_pk_f16_f32 v91, v190, v191
    v_cvt_pk_f16_f32 v99, -v190, -v191
    v_add_f32 v234, 0.5, v234
    v_mul_f32 v235, v233, v234
    v_fmamk_f32 v176, v234, 0x00000000, v235
    v_fmamk_f32 v177, v234, 0x3f800000, v235
    v_fmamk_f32 v178, v234, 0x40000000, v235
    v_fmamk_f32 v179, v234, 0x40400000, v235
    v_fmamk_f32 v180, v234, 0x41800000, v235
    v_fmamk_f32 v181, v234, 0x41880000, v235
    v_fmamk_f32 v182, v234, 0x41900000, v235
    v_fmamk_f32 v183, v234, 0x41980000, v235
    v_sin_f32 v184, v176
    v_cos_f32 v176, v176
    v_sin_f32 v185, v177
    v_cos_f32 v177, v177
    v_sin_f32 v186, v178
    v_cos_f32 v178, v178
    v_sin_f32 v187, v179
    v_cos_f32 v179, v179
    v_sin_f32 v188, v180
    v_cos_f32 v180, v180
    v_sin_f32 v189, v181
    v_cos_f32 v181, v181
    v_sin_f32 v190, v182
    v_cos_f32 v182, v182
    v_sin_f32 v191, v183
    v_cos_f32 v183, v183
    s_waitcnt vmcnt(3)
    s_barrier
    ds_read_b128 v[144:147], v4 offset:0
    ds_read_b128 v[148:151], v4 offset:1024
    ds_read_b128 v[152:155], v4 offset:2048
    ds_read_b128 v[156:159], v4 offset:3072
    ds_read_b128 v[160:163], v4 offset:4096
    ds_read_b128 v[164:167], v4 offset:5120
    ds_read_b128 v[168:171], v4 offset:6144
    ds_read_b128 v[172:175], v4 offset:7168
    v_cvt_pk_f16_f32 v84, v176, v177
    v_cvt_pk_f16_f32 v92, v184, v185
    v_cvt_pk_f16_f32 v100, -v184, -v185
    v_cvt_pk_f16_f32 v85, v178, v179
    v_cvt_pk_f16_f32 v93, v186, v187
    v_cvt_pk_f16_f32 v101, -v186, -v187
    v_cvt_pk_f16_f32 v86, v180, v181
    v_cvt_pk_f16_f32 v94, v188, v189
    v_cvt_pk_f16_f32 v102, -v188, -v189
    v_cvt_pk_f16_f32 v87, v182, v183
    v_cvt_pk_f16_f32 v95, v190, v191
    v_cvt_pk_f16_f32 v103, -v190, -v191
    s_cmp_lg_u32 s42, 0
    s_cbranch_scc1 LB_nospecial
    s_waitcnt lgkmcnt(0)
    s_lshr_b32 s50, s41, 4
    v_lshrrev_b32 v144, s50, v144
    v_and_b32 v144, 0xffff, v144
    v_lshrrev_b32 v145, s50, v145
    v_and_b32 v145, 0xffff, v145
    v_lshrrev_b32 v146, s50, v146
    v_and_b32 v146, 0xffff, v146
    v_lshrrev_b32 v147, s50, v147
    v_and_b32 v147, 0xffff, v147
    v_lshrrev_b32 v148, s50, v148
    v_and_b32 v148, 0xffff, v148
    v_lshrrev_b32 v149, s50, v149
    v_and_b32 v149, 0xffff, v149
    v_lshrrev_b32 v150, s50, v150
    v_and_b32 v150, 0xffff, v150
    v_lshrrev_b32 v151, s50, v151
    v_and_b32 v151, 0xffff, v151
    v_lshrrev_b32 v152, s50, v152
    v_and_b32 v152, 0xffff, v152
    v_lshrrev_b32 v153, s50, v153
    v_and_b32 v153, 0xffff, v153
    v_lshrrev_b32 v154, s50, v154
    v_and_b32 v154, 0xffff, v154
    v_lshrrev_b32 v155, s50, v155
    v_and_b32 v155, 0xffff, v155
    v_lshrrev_b32 v156, s50, v156
    v_and_b32 v156, 0xffff, v156
    v_lshrrev_b32 v157, s50, v157
    v_and_b32 v157, 0xffff, v157
    v_lshrrev_b32 v158, s50, v158
    v_and_b32 v158, 0xffff, v158
    v_lshrrev_b32 v159, s50, v159
    v_and_b32 v159, 0xffff, v159
    v_lshrrev_b32 v160, s50, v160
    v_and_b32 v160, 0xffff, v160
    v_lshrrev_b32 v161, s50, v161
    v_and_b32 v161, 0xffff, v161
    v_lshrrev_b32 v162, s50, v162
    v_and_b32 v162, 0xffff, v162
    v_lshrrev_b32 v163, s50, v163
    v_and_b32 v163, 0xffff, v163
    v_lshrrev_b32 v164, s50, v164
    v_and_b32 v164, 0xffff, v164
    v_lshrrev_b32 v165, s50, v165
    v_and_b32 v165, 0xffff, v165
    v_lshrrev_b32 v166, s50, v166
    v_and_b32 v166, 0xffff, v166
    v_lshrrev_b32 v167, s50, v167
    v_and_b32 v167, 0xffff, v167
    v_lshrrev_b32 v168, s50, v168
    v_and_b32 v168, 0xffff, v168
    v_lshrrev_b32 v169, s50, v169
    v_and_b32 v169, 0xffff, v169
    v_lshrrev_b32 v170, s50, v170
    v_and_b32 v170, 0xffff, v170
    v_lshrrev_b32 v171, s50, v171
    v_and_b32 v171, 0xffff, v171
    v_lshrrev_b32 v172, s50, v172
    v_and_b32 v172, 0xffff, v172
    v_lshrrev_b32 v173, s50, v173
    v_and_b32 v173, 0xffff, v173
    v_lshrrev_b32 v174, s50, v174
    v_and_b32 v174, 0xffff, v174
    v_lshrrev_b32 v175, s50, v175
    v_and_b32 v175, 0xffff, v175
    s_nop 1
LB_nospecial:
    s_waitcnt lgkmcnt(7)
    v_mfma_f32_16x16x32_f16 v[176:179], v[144:147], v[16:19], 0
    v_mfma_f32_16x16x32_f16 v[184:187], v[144:147], v[32:35], 0
    s_waitcnt lgkmcnt(6)
    v_mfma_f32_16x16x32_f16 v[180:183], v[148:151], v[16:19], 0
    v_mfma_f32_16x16x32_f16 v[188:191], v[148:151], v[32:35], 0
    s_waitcnt lgkmcnt(5)
    v_mfma_f32_16x16x32_f16 v[176:179], v[152:155], v[20:23], v[176:179]
    v_mfma_f32_16x16x32_f16 v[184:187], v[152:155], v[36:39], v[184:187]
    s_waitcnt lgkmcnt(4)
    v_mfma_f32_16x16x32_f16 v[180:183], v[156:159], v[20:23], v[180:183]
    v_mfma_f32_16x16x32_f16 v[188:191], v[156:159], v[36:39], v[188:191]
    s_waitcnt vmcnt(0)
    ds_read_b128 v[8:11], v238 offset:8192
    ds_read_b128 v[12:15], v239 offset:8192
    s_waitcnt lgkmcnt(5)
    v_mfma_f32_16x16x32_f16 v[176:179], v[160:163], v[24:27], v[176:179]
    v_mfma_f32_16x16x32_f16 v[184:187], v[160:163], v[40:43], v[184:187]
    s_waitcnt lgkmcnt(4)
    v_mfma_f32_16x16x32_f16 v[180:183], v[164:167], v[24:27], v[180:183]
    v_mfma_f32_16x16x32_f16 v[188:191], v[164:167], v[40:43], v[188:191]
    s_waitcnt lgkmcnt(3)
    v_mfma_f32_16x16x32_f16 v[176:179], v[168:171], v[28:31], v[176:179]
    v_mfma_f32_16x16x32_f16 v[184:187], v[168:171], v[44:47], v[184:187]
    s_waitcnt lgkmcnt(2)
    v_mfma_f32_16x16x32_f16 v[180:183], v[172:175], v[28:31], v[180:183]
    v_mfma_f32_16x16x32_f16 v[188:191], v[172:175], v[44:47], v[188:191]
    v_max_u32 v48, v48, v49
    s_nop 1
    v_max_u32_dpp v48, v48, v48 row_shr:1 row_mask:0xf bank_mask:0xf
    s_nop 1
    v_max_u32_dpp v48, v48, v48 row_shr:2 row_mask:0xf bank_mask:0xf
    s_nop 1
    v_max_u32_dpp v48, v48, v48 row_shr:4 row_mask:0xf bank_mask:0xf
    s_nop 1
    v_max_u32_dpp v48, v48, v48 row_shr:8 row_mask:0xf bank_mask:0xf
    s_nop 1
    v_max_u32_dpp v48, v48, v48 row_bcast:15 row_mask:0xa bank_mask:0xf
    s_nop 1
    v_max_u32_dpp v48, v48, v48 row_bcast:31 row_mask:0xc bank_mask:0xf
    s_nop 0
    v_readlane_b32 s52, v48, 63
    s_waitcnt lgkmcnt(1)
    v_lshlrev_b32 v216, 16, v8
    v_and_b32 v224, 0xffff0000, v8
    v_lshlrev_b32 v217, 16, v9
    v_and_b32 v225, 0xffff0000, v9
    v_lshlrev_b32 v218, 16, v10
    v_and_b32 v226, 0xffff0000, v10
    v_lshlrev_b32 v219, 16, v11
    v_and_b32 v227, 0xffff0000, v11
    s_waitcnt lgkmcnt(0)
    v_lshlrev_b32 v220, 16, v12
    v_and_b32 v228, 0xffff0000, v12
    v_lshlrev_b32 v221, 16, v13
    v_and_b32 v229, 0xffff0000, v13
    v_lshlrev_b32 v222, 16, v14
    v_and_b32 v230, 0xffff0000, v14
    v_lshlrev_b32 v223, 16, v15
    v_and_b32 v231, 0xffff0000, v15
    s_lshr_b32 s52, s52, 7
    s_sub_u32 s52, 255, s52
    s_min_i32 s52, s52, 250
    s_max_i32 s52, s52, 1
    s_sub_u32 s54, 251, s52
    s_lshl_b32 s52, s52, 23
    s_lshl_b32 s54, s54, 23
    v_pk_mul_f32 v[216:217], v[216:217], s[52:53] op_sel_hi:[1,0]
    v_pk_mul_f32 v[224:225], v[224:225], s[52:53] op_sel_hi:[1,0]
    v_pk_mul_f32 v[218:219], v[218:219], s[52:53] op_sel_hi:[1,0]
    v_pk_mul_f32 v[226:227], v[226:227], s[52:53] op_sel_hi:[1,0]
    v_pk_mul_f32 v[220:221], v[220:221], s[52:53] op_sel_hi:[1,0]
    v_pk_mul_f32 v[228:229], v[228:229], s[52:53] op_sel_hi:[1,0]
    v_pk_mul_f32 v[222:223], v[222:223], s[52:53] op_sel_hi:[1,0]
    v_pk_mul_f32 v[230:231], v[230:231], s[52:53] op_sel_hi:[1,0]
    v_pk_mul_f32 v[192:193], v[176:177], v[128:129]
    v_pk_mul_f32 v[200:201], v[184:185], v[128:129]
    v_pk_mul_f32 v[194:195], v[178:179], v[130:131]
    v_pk_mul_f32 v[202:203], v[186:187], v[130:131]
    v_pk_mul_f32 v[196:197], v[180:181], v[132:133]
    v_pk_mul_f32 v[204:205], v[188:189], v[132:133]
    v_pk_mul_f32 v[198:199], v[182:183], v[134:135]
    v_pk_mul_f32 v[206:207], v[190:191], v[134:135]
    v_pk_fma_f32 v[192:193], v[184:185], v[136:137], v[192:193]
    v_pk_fma_f32 v[200:201], v[176:177], v[136:137], v[200:201] neg_lo:[1,0,0] neg_hi:[1,0,0]
    v_pk_fma_f32 v[194:195], v[186:187], v[138:139], v[194:195]
    v_pk_fma_f32 v[202:203], v[178:179], v[138:139], v[202:203] neg_lo:[1,0,0] neg_hi:[1,0,0]
    v_pk_fma_f32 v[196:197], v[188:189], v[140:141], v[196:197]
    v_pk_fma_f32 v[204:205], v[180:181], v[140:141], v[204:205] neg_lo:[1,0,0] neg_hi:[1,0,0]
    v_pk_fma_f32 v[198:199], v[190:191], v[142:143], v[198:199]
    v_pk_fma_f32 v[206:207], v[182:183], v[142:143], v[206:207] neg_lo:[1,0,0] neg_hi:[1,0,0]
    v_cvt_pk_f16_f32 v208, v192, v193
    v_cvt_pk_f16_f32 v212, v200, v201
    v_cvt_pk_f16_f32 v209, v194, v195
    v_cvt_pk_f16_f32 v213, v202, v203
    v_cvt_pk_f16_f32 v210, v196, v197
    v_cvt_pk_f16_f32 v214, v204, v205
    v_cvt_pk_f16_f32 v211, v198, v199
    v_cvt_pk_f16_f32 v215, v206, v207
    s_nop 0
    v_mfma_f32_16x16x32_f16 v[176:179], v[80:83], v[208:211], 0
    v_mfma_f32_16x16x32_f16 v[184:187], v[80:83], v[212:215], 0
    v_mfma_f32_16x16x32_f16 v[180:183], v[84:87], v[208:211], 0
    v_mfma_f32_16x16x32_f16 v[188:191], v[84:87], v[212:215], 0
    v_mfma_f32_16x16x32_f16 v[176:179], v[88:91], v[212:215], v[176:179]
    v_mfma_f32_16x16x32_f16 v[184:187], v[96:99], v[208:211], v[184:187]
    v_mfma_f32_16x16x32_f16 v[180:183], v[92:95], v[212:215], v[180:183]
    v_mfma_f32_16x16x32_f16 v[188:191], v[100:103], v[208:211], v[188:191]
    s_nop 4
    v_pk_mul_f32 v[192:193], v[176:177], v[216:217]
    v_pk_mul_f32 v[200:201], v[184:185], v[216:217]
    v_pk_mul_f32 v[194:195], v[178:179], v[218:219]
    v_pk_mul_f32 v[202:203], v[186:187], v[218:219]
    v_pk_mul_f32 v[196:197], v[180:181], v[220:221]
    v_pk_mul_f32 v[204:205], v[188:189], v[220:221]
    v_pk_mul_f32 v[198:199], v[182:183], v[222:223]
    v_pk_mul_f32 v[206:207], v[190:191], v[222:223]
    v_pk_fma_f32 v[192:193], v[184:185], v[224:225], v[192:193] neg_lo:[1,0,0] neg_hi:[1,0,0]
    v_pk_fma_f32 v[200:201], v[176:177], v[224:225], v[200:201]
    v_pk_fma_f32 v[194:195], v[186:187], v[226:227], v[194:195] neg_lo:[1,0,0] neg_hi:[1,0,0]
    v_pk_fma_f32 v[202:203], v[178:179], v[226:227], v[202:203]
    v_pk_fma_f32 v[196:197], v[188:189], v[228:229], v[196:197] neg_lo:[1,0,0] neg_hi:[1,0,0]
    v_pk_fma_f32 v[204:205], v[180:181], v[228:229], v[204:205]
    v_pk_fma_f32 v[198:199], v[190:191], v[230:231], v[198:199] neg_lo:[1,0,0] neg_hi:[1,0,0]
    v_pk_fma_f32 v[206:207], v[182:183], v[230:231], v[206:207]
    v_cvt_pk_f16_f32 v208, v192, v193
    v_cvt_pk_f16_f32 v212, -v200, -v201
    v_cvt_pk_f16_f32 v209, v194, v195
    v_cvt_pk_f16_f32 v213, -v202, -v203
    v_cvt_pk_f16_f32 v210, v196, v197
    v_cvt_pk_f16_f32 v214, -v204, -v205
    v_cvt_pk_f16_f32 v211, v198, v199
    v_cvt_pk_f16_f32 v215, -v206, -v207
    s_nop 0
    v_mfma_f32_16x16x32_f16 v[176:179], v[80:83], v[208:211], 0
    v_mfma_f32_16x16x32_f16 v[184:187], v[80:83], v[212:215], 0
    v_mfma_f32_16x16x32_f16 v[180:183], v[84:87], v[208:211], 0
    v_mfma_f32_16x16x32_f16 v[188:191], v[84:87], v[212:215], 0
    v_mfma_f32_16x16x32_f16 v[176:179], v[88:91], v[212:215], v[176:179]
    v_mfma_f32_16x16x32_f16 v[184:187], v[96:99], v[208:211], v[184:187]
    v_mfma_f32_16x16x32_f16 v[180:183], v[92:95], v[212:215], v[180:183]
    v_mfma_f32_16x16x32_f16 v[188:191], v[100:103], v[208:211], v[188:191]
    s_nop 4
    v_pk_mul_f32 v[192:193], v[176:177], v[128:129]
    v_pk_mul_f32 v[200:201], v[184:185], v[128:129]
    v_pk_mul_f32 v[194:195], v[178:179], v[130:131]
    v_pk_mul_f32 v[202:203], v[186:187], v[130:131]
    v_pk_mul_f32 v[196:197], v[180:181], v[132:133]
    v_pk_mul_f32 v[204:205], v[188:189], v[132:133]
    v_pk_mul_f32 v[198:199], v[182:183], v[134:135]
    v_pk_mul_f32 v[206:207], v[190:191], v[134:135]
    v_pk_fma_f32 v[192:193], v[184:185], v[136:137], v[192:193]
    v_pk_fma_f32 v[200:201], v[176:177], v[136:137], v[200:201] neg_lo:[1,0,0] neg_hi:[1,0,0]
    v_pk_fma_f32 v[194:195], v[186:187], v[138:139], v[194:195]
    v_pk_fma_f32 v[202:203], v[178:179], v[138:139], v[202:203] neg_lo:[1,0,0] neg_hi:[1,0,0]
    v_pk_fma_f32 v[196:197], v[188:189], v[140:141], v[196:197]
    v_pk_fma_f32 v[204:205], v[180:181], v[140:141], v[204:205] neg_lo:[1,0,0] neg_hi:[1,0,0]
    v_pk_fma_f32 v[198:199], v[190:191], v[142:143], v[198:199]
    v_pk_fma_f32 v[206:207], v[182:183], v[142:143], v[206:207] neg_lo:[1,0,0] neg_hi:[1,0,0]
    v_cvt_pk_f16_f32 v216, v192, v200
    ds_write_b32 v5, v216 offset:16384
    v_cvt_pk_f16_f32 v217, v193, v201
    ds_write_b32 v5, v217 offset:16656
    v_cvt_pk_f16_f32 v218, v194, v202
    ds_write_b32 v5, v218 offset:16928
    v_cvt_pk_f16_f32 v219, v195, v203
    ds_write_b32 v5, v219 offset:17200
    v_cvt_pk_f16_f32 v220, v196, v204
    ds_write_b32 v5, v220 offset:20736
    v_cvt_pk_f16_f32 v221, v197, v205
    ds_write_b32 v5, v221 offset:21008
    v_cvt_pk_f16_f32 v222, v198, v206
    ds_write_b32 v5, v222 offset:21280
    v_cvt_pk_f16_f32 v223, v199, v207
    ds_write_b32 v5, v223 offset:21552
    s_waitcnt lgkmcnt(0)
    s_barrier
    ds_read_b128 v[144:147], v6 offset:16384
    ds_read_b128 v[148:151], v6 offset:20736
    ds_read_b128 v[152:155], v6 offset:16448
    ds_read_b128 v[156:159], v6 offset:20800
    ds_read_b128 v[160:163], v6 offset:16512
    ds_read_b128 v[164:167], v6 offset:20864
    ds_read_b128 v[168:171], v6 offset:16576
    ds_read_b128 v[172:175], v6 offset:20928
    s_waitcnt lgkmcnt(7)
    v_mfma_f32_16x16x32_f16 v[176:179], v[16:19], v[144:147], 0
    v_mfma_f32_16x16x32_f16 v[184:187], v[32:35], v[144:147], 0
    s_waitcnt lgkmcnt(6)
    v_mfma_f32_16x16x32_f16 v[180:183], v[16:19], v[148:151], 0
    v_mfma_f32_16x16x32_f16 v[188:191], v[32:35], v[148:151], 0
    s_waitcnt lgkmcnt(5)
    v_mfma_f32_16x16x32_f16 v[176:179], v[20:23], v[152:155], v[176:179]
    v_mfma_f32_16x16x32_f16 v[184:187], v[36:39], v[152:155], v[184:187]
    s_waitcnt lgkmcnt(4)
    v_mfma_f32_16x16x32_f16 v[180:183], v[20:23], v[156:159], v[180:183]
    v_mfma_f32_16x16x32_f16 v[188:191], v[36:39], v[156:159], v[188:191]
    s_waitcnt lgkmcnt(3)
    v_mfma_f32_16x16x32_f16 v[176:179], v[24:27], v[160:163], v[176:179]
    v_mfma_f32_16x16x32_f16 v[184:187], v[40:43], v[160:163], v[184:187]
    s_waitcnt lgkmcnt(2)
    v_mfma_f32_16x16x32_f16 v[180:183], v[24:27], v[164:167], v[180:183]
    v_mfma_f32_16x16x32_f16 v[188:191], v[40:43], v[164:167], v[188:191]
    s_waitcnt lgkmcnt(1)
    v_mfma_f32_16x16x32_f16 v[176:179], v[28:31], v[168:171], v[176:179]
    v_mfma_f32_16x16x32_f16 v[184:187], v[44:47], v[168:171], v[184:187]
    s_waitcnt lgkmcnt(0)
    v_mfma_f32_16x16x32_f16 v[180:183], v[28:31], v[172:175], v[180:183]
    v_mfma_f32_16x16x32_f16 v[188:191], v[44:47], v[172:175], v[188:191]
    s_nop 3
    v_cvt_pk_f16_f32 v192, v176, v177
    v_cvt_pk_f16_f32 v193, v178, v179
    v_cvt_pk_f16_f32 v194, -v184, -v185
    v_cvt_pk_f16_f32 v195, -v186, -v187
    v_cvt_pk_f16_f32 v196, v180, v181
    v_cvt_pk_f16_f32 v197, v182, v183
    v_cvt_pk_f16_f32 v198, -v188, -v189
    v_cvt_pk_f16_f32 v199, -v190, -v191
    s_cmp_eq_u32 s42, 0
    s_cbranch_scc1 LB_st_special
    buffer_store_dwordx4 v[192:195], v7, s[20:23], s48 offen sc1
    buffer_store_dwordx4 v[196:199], v7, s[20:23], s49 offen sc1
    s_endpgm
LB_st_special:
    v_mov_b32 v48, s54
    v_cmp_eq_u32 vcc, 0, v0
    v_mov_b32 v49, 1073741824
    s_nop 0
    v_cndmask_b32 v49, v49, 0, vcc
    s_mov_b32 s55, 21643776
    buffer_store_dword v48, v49, s[20:23], s55 offen sc1
    s_lshr_b32 s50, s41, 5
    v_add_u32 v7, s50, v7
    buffer_store_dwordx2 v[192:193], v7, s[20:23], s48 offen sc1
    buffer_store_dwordx2 v[196:197], v7, s[20:23], s49 offen sc1
    s_endpgm
LB_pack:
    s_waitcnt lgkmcnt(0)
    s_mov_b32 s20, s10
    s_and_b32 s21, s11, 0xffff
    s_mov_b32 s22, 25165824
    s_mov_b32 s23, 0x20000
    s_cmp_ge_u32 s2, 385
    s_cbranch_scc1 LB_pack2
    s_cmp_ge_u32 s40, 2
    s_cbranch_scc1 LB_end
    s_mov_b32 s32, s12
    s_and_b32 s33, s13, 0xffff
    s_mov_b32 s34, 1835008
    s_mov_b32 s35, 0x20000
    s_sub_u32 s41, s2, 257
    s_lshl_b32 s41, s41, 1
    s_add_u32 s41, s41, s40
    s_and_b32 s42, s41, 15
    s_lshr_b32 s43, s41, 4
    s_lshl_b32 s41, s42, 4
    s_add_u32 s41, s41, s43
    s_mul_i32 s44, s43, 114688
    s_mul_i32 s45, s42, 224
    s_add_u32 s44, s44, s45
    s_mul_i32 s50, s40, 7168
    v_mov_b32 v15, v1
    v_mul_u32_u24 v4, 4682, v15
    v_lshrrev_b32 v4, 16, v4
    v_mul_u32_u24 v5, 14, v4
    v_sub_u32 v5, v15, v5
    v_mul_u32_u24 v4, 3584, v4
    v_lshl_add_u32 v4, v5, 4, v4
    s_add_u32 m0, s50, 0
    s_nop 0
    buffer_load_dwordx4 v4, s[32:35], s44 offen nt lds
    v_add_u32 v15, 64, v1
    v_mul_u32_u24 v4, 4682, v15
    v_lshrrev_b32 v4, 16, v4
    v_mul_u32_u24 v5, 14, v4
    v_sub_u32 v5, v15, v5
    v_mul_u32_u24 v4, 3584, v4
    v_lshl_add_u32 v4, v5, 4, v4
    s_add_u32 m0, s50, 1024
    s_nop 0
    buffer_load_dwordx4 v4, s[32:35], s44 offen nt lds
    v_add_u32 v15, 128, v1
    v_mul_u32_u24 v4, 4682, v15
    v_lshrrev_b32 v4, 16, v4
    v_mul_u32_u24 v5, 14, v4
    v_sub_u32 v5, v15, v5
    v_mul_u32_u24 v4, 3584, v4
    v_lshl_add_u32 v4, v5, 4, v4
    s_add_u32 m0, s50, 2048
    s_nop 0
    buffer_load_dwordx4 v4, s[32:35], s44 offen nt lds
    v_add_u32 v15, 192, v1
    v_mul_u32_u24 v4, 4682, v15
    v_lshrrev_b32 v4, 16, v4
    v_mul_u32_u24 v5, 14, v4
    v_sub_u32 v5, v15, v5
    v_mul_u32_u24 v4, 3584, v4
    v_lshl_add_u32 v4, v5, 4, v4
    s_add_u32 m0, s50, 3072
    s_nop 0
    buffer_load_dwordx4 v4, s[32:35], s44 offen nt lds
    v_add_u32 v15, 256, v1
    v_mul_u32_u24 v4, 4682, v15
    v_lshrrev_b32 v4, 16, v4
    v_mul_u32_u24 v5, 14, v4
    v_sub_u32 v5, v15, v5
    v_mul_u32_u24 v4, 3584, v4
    v_lshl_add_u32 v4, v5, 4, v4
    s_add_u32 m0, s50, 4096
    s_nop 0
    buffer_load_dwordx4 v4, s[32:35], s44 offen nt lds
    v_add_u32 v15, 320, v1
    v_mul_u32_u24 v4, 4682, v15
    v_lshrrev_b32 v4, 16, v4
    v_mul_u32_u24 v5, 14, v4
    v_sub_u32 v5, v15, v5
    v_mul_u32_u24 v4, 3584, v4
    v_lshl_add_u32 v4, v5, 4, v4
    s_add_u32 m0, s50, 5120
    s_nop 0
    buffer_load_dwordx4 v4, s[32:35], s44 offen nt lds
    v_add_u32 v15, 384, v1
    v_mul_u32_u24 v4, 4682, v15
    v_lshrrev_b32 v4, 16, v4
    v_mul_u32_u24 v5, 14, v4
    v_sub_u32 v5, v15, v5
    v_mul_u32_u24 v4, 3584, v4
    v_lshl_add_u32 v4, v5, 4, v4
    s_add_u32 m0, s50, 6144
    s_nop 0
    buffer_load_dwordx4 v4, s[32:35], s44 offen nt lds
    v_bfe_u32 v5, v1, 2, 2
    v_lshl_add_u32 v5, v3, 2, v5
    v_mul_u32_u24 v5, 224, v5
    v_and_b32 v6, 3, v1
    v_lshl_add_u32 v5, v6, 3, v5
    v_add_u32 v5, s50, v5
    v_lshlrev_b32 v7, 4, v1
    s_mul_i32 s46, s41, 7168
    s_add_u32 s46, s46, 19775488
    s_add_u32 s47, s46, 4096
    s_waitcnt vmcnt(0)
    ds_read_b64_tr_b16 v[16:17], v5 offset:0
    ds_read_b64_tr_b16 v[18:19], v5 offset:3584
    ds_read_b64_tr_b16 v[20:21], v5 offset:32
    ds_read_b64_tr_b16 v[22:23], v5 offset:3616
    ds_read_b64_tr_b16 v[24:25], v5 offset:64
    ds_read_b64_tr_b16 v[26:27], v5 offset:3648
    ds_read_b64_tr_b16 v[28:29], v5 offset:96
    ds_read_b64_tr_b16 v[30:31], v5 offset:3680
    ds_read_b64_tr_b16 v[32:33], v5 offset:128
    ds_read_b64_tr_b16 v[34:35], v5 offset:3712
    ds_read_b64_tr_b16 v[36:37], v5 offset:160
    ds_read_b64_tr_b16 v[38:39], v5 offset:3744
    ds_read_b64_tr_b16 v[40:41], v5 offset:192
    ds_read_b64_tr_b16 v[42:43], v5 offset:3776
    s_waitcnt lgkmcnt(12)
    buffer_store_dwordx4 v[16:19], v7, s[20:23], s46 offen offset:0 sc1
    s_waitcnt lgkmcnt(10)
    buffer_store_dwordx4 v[20:23], v7, s[20:23], s46 offen offset:1024 sc1
    s_waitcnt lgkmcnt(8)
    buffer_store_dwordx4 v[24:27], v7, s[20:23], s46 offen offset:2048 sc1
    s_waitcnt lgkmcnt(6)
    buffer_store_dwordx4 v[28:31], v7, s[20:23], s46 offen offset:3072 sc1
    s_waitcnt lgkmcnt(4)
    buffer_store_dwordx4 v[32:35], v7, s[20:23], s47 offen offset:0 sc1
    s_waitcnt lgkmcnt(2)
    buffer_store_dwordx4 v[36:39], v7, s[20:23], s47 offen offset:1024 sc1
    s_waitcnt lgkmcnt(0)
    buffer_store_dwordx4 v[40:43], v7, s[20:23], s47 offen offset:2048 sc1
    s_endpgm
LB_pack2:
    s_mov_b32 s36, s14
    s_and_b32 s37, s15, 0xffff
    s_mov_b32 s38, 1835008
    s_mov_b32 s39, 0x20000
    s_sub_u32 s41, s2, 385
    s_lshl_b32 s41, s41, 2
    s_add_u32 s41, s41, s40
    s_lshr_b32 s42, s41, 3
    s_and_b32 s43, s41, 7
    s_mul_i32 s44, s42, 37
    s_lshr_b32 s44, s44, 8
    s_mul_i32 s45, s44, 7
    s_sub_u32 s45, s42, s45
    s_mul_i32 s44, s44, 224
    s_cmp_ge_u32 s45, 3
    s_cselect_b32 s46, 16, 0
    s_lshl_b32 s47, s45, 5
    s_add_u32 s46, s46, s47
    s_cmp_eq_u32 s45, 6
    s_cselect_b32 s46, 96, s46
    s_cselect_b32 s47, 112, 16
    s_add_u32 s44, s44, s46
    s_lshl_b32 s44, s44, 10
    s_lshl_b32 s49, s43, 7
    s_add_u32 s44, s44, s49
    v_lshrrev_b32 v5, 5, v1
    v_mul_u32_u24 v5, s47, v5
    v_bfe_u32 v6, v1, 3, 2
    v_add_u32 v5, v5, v6
    v_lshlrev_b32 v5, 10, v5
    v_and_b32 v6, 7, v1
    v_lshl_add_u32 v5, v6, 4, v5
    s_lshl_b32 s50, s40, 12
    s_add_u32 m0, s50, 0
    s_nop 0
    buffer_load_dwordx4 v5, s[36:39], s44 offen nt lds
    s_add_u32 s44, s44, 4096
    s_add_u32 m0, s50, 1024
    s_nop 0
    buffer_load_dwordx4 v5, s[36:39], s44 offen nt lds
    s_add_u32 s44, s44, 4096
    s_add_u32 m0, s50, 2048
    s_nop 0
    buffer_load_dwordx4 v5, s[36:39], s44 offen nt lds
    s_add_u32 s44, s44, 4096
    s_add_u32 m0, s50, 3072
    s_nop 0
    buffer_load_dwordx4 v5, s[36:39], s44 offen nt lds
    v_bfe_u32 v6, v1, 2, 2
    v_lshl_add_u32 v6, v3, 3, v6
    v_lshlrev_b32 v6, 7, v6
    v_and_b32 v7, 3, v1
    v_lshl_add_u32 v6, v7, 3, v6
    v_add_u32 v6, s50, v6
    v_lshlrev_b32 v7, 4, v1
    s_mul_i32 s46, s43, 56
    s_add_u32 s46, s46, s42
    s_lshl_b32 s46, s46, 12
    s_add_u32 s46, s46, 10600448
    s_waitcnt vmcnt(0)
    ds_read_b64_tr_b16 v[16:17], v6 offset:0
    ds_read_b64_tr_b16 v[18:19], v6 offset:512
    ds_read_b64_tr_b16 v[20:21], v6 offset:32
    ds_read_b64_tr_b16 v[22:23], v6 offset:544
    ds_read_b64_tr_b16 v[24:25], v6 offset:64
    ds_read_b64_tr_b16 v[26:27], v6 offset:576
    ds_read_b64_tr_b16 v[28:29], v6 offset:96
    ds_read_b64_tr_b16 v[30:31], v6 offset:608
    s_waitcnt lgkmcnt(6)
    buffer_store_dwordx4 v[16:19], v7, s[20:23], s46 offen offset:0 sc1
    s_waitcnt lgkmcnt(4)
    buffer_store_dwordx4 v[20:23], v7, s[20:23], s46 offen offset:1024 sc1
    s_waitcnt lgkmcnt(2)
    buffer_store_dwordx4 v[24:27], v7, s[20:23], s46 offen offset:2048 sc1
    s_waitcnt lgkmcnt(0)
    buffer_store_dwordx4 v[28:31], v7, s[20:23], s46 offen offset:3072 sc1
    s_endpgm
LB_end:
    s_endpgm

.section .rodata,"a"
.p2align 6
.amdhsa_kernel kb_kernel
  .amdhsa_next_free_vgpr 240
  .amdhsa_next_free_sgpr 56
  .amdhsa_accum_offset 240
  .amdhsa_group_segment_fixed_size 0
  .amdhsa_kernarg_size 72
  .amdhsa_user_sgpr_count 2
  .amdhsa_user_sgpr_kernarg_segment_ptr 1
  .amdhsa_system_sgpr_workgroup_id_x 1
.end_amdhsa_kernel
.text
.globl kf_kernel
.p2align 8
.type kf_kernel,@function
kf_kernel:
    s_load_dwordx2 s[4:5], s[0:1], 0
    s_load_dwordx2 s[8:9], s[0:1], 48
    s_load_dwordx2 s[10:11], s[0:1], 64
    s_cmp_ge_u32 s2, 256
    s_cbranch_scc1 LF_end
    v_and_b32 v1, 63, v0
    v_lshrrev_b32 v4, 6, v0
    v_and_b32 v2, 15, v0
    v_readfirstlane_b32 s40, v4
    v_lshrrev_b32 v3, 4, v1
    s_and_b32 s41, s2, 6
    s_lshl_b32 s41, s41, 1
    s_lshr_b32 s42, s2, 6
    s_add_u32 s41, s41, s42
    s_and_b32 s43, s2, 1
    s_lshl_b32 s43, s43, 3
    s_lshr_b32 s42, s2, 3
    s_and_b32 s42, s42, 7
    s_add_u32 s43, s43, s42
    s_lshr_b32 s62, s43, 3
    s_lshl_b32 s62, s62, 2
    s_and_b32 s44, s43, 3
    s_add_u32 s62, s62, s44
    s_lshr_b32 s63, s43, 2
    s_and_b32 s63, s63, 1
    v_lshlrev_b32 v14, 4, v1
    s_cmp_ge_u32 s40, 4
    s_cbranch_scc1 LF_L
    s_setprio 1
    s_lshr_b32 s42, s41, 3
    s_lshl_b32 s42, s42, 2
    s_add_u32 s42, s42, s44
    s_and_b32 s44, s41, 7
    s_lshl_b32 s44, s44, 2
    s_lshr_b32 s45, s43, 2
    s_add_u32 s44, s44, s45
    s_lshl_b32 s45, s44, 8
    s_lshl_b32 s46, s42, 5
    s_add_u32 s45, s45, s46
    s_add_u32 s45, s45, 4243456
    v_bfe_u32 v5, v1, 1, 4
    v_lshrrev_b32 v6, 5, v1
    s_lshl_b32 s46, s40, 2
    v_add_u32 v6, s46, v6
    v_and_b32 v7, 7, v5
    v_lshlrev_b32 v7, 5, v7
    v_and_b32 v12, 1, v1
    v_lshlrev_b32 v12, 4, v12
    v_cmp_gt_u32 s[46:47], 8, v5
    s_mov_b32 s48, 8448
    v_sub_u32 v9, 32, v6
    v_cmp_eq_u32 vcc, 0, v6
    s_nop 1
    v_cndmask_b32 v9, v9, 16, vcc
    v_cndmask_b32 v9, v9, v6, s[46:47]
    v_add_u32 v9, v9, v7
    v_mad_u32_u24 v10, v9, s48, v12
    v_add_u32 v6, 2, v6
    v_sub_u32 v9, 32, v6
    v_cmp_eq_u32 vcc, 0, v6
    s_nop 1
    v_cndmask_b32 v9, v9, 16, vcc
    v_cndmask_b32 v9, v9, v6, s[46:47]
    v_add_u32 v9, v9, v7
    v_mad_u32_u24 v11, v9, s48, v12
    s_lshl_b32 s48, s42, 8
    s_lshl_b32 s49, s40, 6
    s_add_u32 s48, s48, s49
    s_add_u32 s48, s48, s44
    s_lshl_b32 s48, s48, 10
    s_add_u32 s49, s48, 32768
    v_lshlrev_b32 v13, 5, v2
    v_lshl_add_u32 v13, v3, 3, v13
    s_lshl_b32 s50, s40, 11
    v_lshrrev_b32 v64, 1, v2
    v_cvt_f32_u32 v64, v64
    v_add_f32 v65, 0x41000000, v64
    v_mul_f32 v66, 0x3d800000, v64
    v_mul_f32 v67, 0x3d800000, v65
    v_mul_f32 v64, 0x3b000000, v64
    v_mul_f32 v65, 0x3b000000, v65
    v_cmp_gt_u32 s[46:47], 2, v3
    v_and_b32 v68, 1, v2
    v_cmp_eq_u32 s[54:55], 1, v68
    v_mov_b32 v69, 0x3e800000
    v_mov_b32 v70, 0xbe800000
    v_cndmask_b32 v69, v69, v70, s[46:47]
    v_cndmask_b32 v69, 0, v69, s[54:55]
    v_and_b32 v70, 1, v3
    v_lshlrev_b32 v70, 7, v70
    s_waitcnt lgkmcnt(0)
    s_mov_b32 s20, s10
    s_and_b32 s21, s11, 0xffff
    s_mov_b32 s22, 25165824
    s_mov_b32 s23, 0x20000
    s_mov_b32 s16, s4
    s_and_b32 s17, s5, 0xffff
    s_mov_b32 s18, 2097152
    s_mov_b32 s19, 0x20000
    s_add_u32 m0, s50, 114688
    s_nop 0
    buffer_load_dwordx4 v10, s[20:23], s45 offen lds
    s_add_u32 m0, s50, 115712
    s_nop 0
    buffer_load_dwordx4 v11, s[20:23], s45 offen lds
    buffer_load_dwordx2 v[16:17], v13, s[16:19], s48 offen offset:0
    buffer_load_dwordx2 v[18:19], v13, s[16:19], s48 offen offset:512
    buffer_load_dwordx2 v[20:21], v13, s[16:19], s49 offen offset:0
    buffer_load_dwordx2 v[22:23], v13, s[16:19], s49 offen offset:512
    v_mov_b32 v15, 0
    s_mov_b32 s60, 21643776
    buffer_load_dword v15, v15, s[20:23], s60 offen
    s_mov_b32 s28, s8
    s_and_b32 s29, s9, 0xffff
    s_mov_b32 s30, 2097152
    s_mov_b32 s31, 0x20000
    s_lshl_b32 s56, s40, 2
    s_sub_u32 s57, 32, s56
    s_cmp_eq_u32 s56, 0
    s_cselect_b32 s57, 16, s57
    s_cselect_b32 s58, 0, 1.0
    v_mul_f32 v78, s58, v69
    v_mov_b32 v71, s57
    v_mov_b32 v72, s56
    v_cndmask_b32 v71, v71, v72, s[46:47]
    v_add_u32 v71, v71, v70
    v_cvt_f32_u32 v71, v71
    v_fma_f32 v80, v64, v71, v78
    v_fma_f32 v84, v65, v71, v78
    v_fmamk_f32 v81, v66, 0x3f800000, v80
    v_fmamk_f32 v82, v66, 0x40000000, v80
    v_fmamk_f32 v83, v66, 0x40400000, v80
    v_fmamk_f32 v85, v67, 0x3f800000, v84
    v_fmamk_f32 v86, v67, 0x40000000, v84
    v_fmamk_f32 v87, v67, 0x40400000, v84
    v_sin_f32 v88, v80
    v_cos_f32 v80, v80
    v_sin_f32 v89, v81
    v_cos_f32 v81, v81
    v_sin_f32 v90, v82
    v_cos_f32 v82, v82
    v_sin_f32 v91, v83
    v_cos_f32 v83, v83
    v_sin_f32 v92, v84
    v_cos_f32 v84, v84
    v_sin_f32 v93, v85
    v_cos_f32 v85, v85
    v_sin_f32 v94, v86
    v_cos_f32 v86, v86
    v_sin_f32 v95, v87
    v_cos_f32 v87, v87
    v_cvt_pk_f16_f32 v24, v80, -v88
    v_cvt_pk_f16_f32 v25, v81, -v89
    v_cvt_pk_f16_f32 v26, v82, -v90
    v_cvt_pk_f16_f32 v27, v83, -v91
    v_cvt_pk_f16_f32 v28, v84, -v92
    v_cvt_pk_f16_f32 v29, v85, -v93
    v_cvt_pk_f16_f32 v30, v86, -v94
    v_cvt_pk_f16_f32 v31, v87, -v95
    s_lshl_b32 s56, s40, 2
    s_add_u32 s56, s56, 1
    s_sub_u32 s57, 32, s56
    v_mov_b32 v71, s57
    v_mov_b32 v72, s56
    v_cndmask_b32 v71, v71, v72, s[46:47]
    v_add_u32 v71, v71, v70
    v_cvt_f32_u32 v71, v71
    v_fma_f32 v80, v64, v71, v69
    v_fma_f32 v84, v65, v71, v69
    v_fmamk_f32 v81, v66, 0x3f800000, v80
    v_fmamk_f32 v82, v66, 0x40000000, v80
    v_fmamk_f32 v83, v66, 0x40400000, v80
    v_fmamk_f32 v85, v67, 0x3f800000, v84
    v_fmamk_f32 v86, v67, 0x40000000, v84
    v_fmamk_f32 v87, v67, 0x40400000, v84
    v_sin_f32 v88, v80
    v_cos_f32 v80, v80
    v_sin_f32 v89, v81
    v_cos_f32 v81, v81
    v_sin_f32 v90, v82
    v_cos_f32 v82, v82
    v_sin_f32 v91, v83
    v_cos_f32 v83, v83
    v_sin_f32 v92, v84
    v_cos_f32 v84, v84
    v_sin_f32 v93, v85
    v_cos_f32 v85, v85
    v_sin_f32 v94, v86
    v_cos_f32 v86, v86
    v_sin_f32 v95, v87
    v_cos_f32 v87, v87
    v_cvt_pk_f16_f32 v32, v80, -v88
    v_cvt_pk_f16_f32 v33, v81, -v89
    v_cvt_pk_f16_f32 v34, v82, -v90
    v_cvt_pk_f16_f32 v35, v83, -v91
    v_cvt_pk_f16_f32 v36, v84, -v92
    v_cvt_pk_f16_f32 v37, v85, -v93
    v_cvt_pk_f16_f32 v38, v86, -v94
    v_cvt_pk_f16_f32 v39, v87, -v95
    s_lshl_b32 s56, s40, 2
    s_add_u32 s56, s56, 2
    s_sub_u32 s57, 32, s56
    v_mov_b32 v71, s57
    v_mov_b32 v72, s56
    v_cndmask_b32 v71, v71, v72, s[46:47]
    v_add_u32 v71, v71, v70
    v_cvt_f32_u32 v71, v71
    v_fma_f32 v80, v64, v71, v69
    v_fma_f32 v84, v65, v71, v69
    v_fmamk_f32 v81, v66, 0x3f800000, v80
    v_fmamk_f32 v82, v66, 0x40000000, v80
    v_fmamk_f32 v83, v66, 0x40400000, v80
    v_fmamk_f32 v85, v67, 0x3f800000, v84
    v_fmamk_f32 v86, v67, 0x40000000, v84
    v_fmamk_f32 v87, v67, 0x40400000, v84
    v_sin_f32 v88, v80
    v_cos_f32 v80, v80
    v_sin_f32 v89, v81
    v_cos_f32 v81, v81
    v_sin_f32 v90, v82
    v_cos_f32 v82, v82
    v_sin_f32 v91, v83
    v_cos_f32 v83, v83
    v_sin_f32 v92, v84
    v_cos_f32 v84, v84
    v_sin_f32 v93, v85
    v_cos_f32 v85, v85
    v_sin_f32 v94, v86
    v_cos_f32 v86, v86
    v_sin_f32 v95, v87
    v_cos_f32 v87, v87
    v_cvt_pk_f16_f32 v40, v80, -v88
    v_cvt_pk_f16_f32 v41, v81, -v89
    v_cvt_pk_f16_f32 v42, v82, -v90
    v_cvt_pk_f16_f32 v43, v83, -v91
    v_cvt_pk_f16_f32 v44, v84, -v92
    v_cvt_pk_f16_f32 v45, v85, -v93
    v_cvt_pk_f16_f32 v46, v86, -v94
    v_cvt_pk_f16_f32 v47, v87, -v95
    s_lshl_b32 s56, s40, 2
    s_add_u32 s56, s56, 3
    s_sub_u32 s57, 32, s56
    v_mov_b32 v71, s57
    v_mov_b32 v72, s56
    v_cndmask_b32 v71, v71, v72, s[46:47]
    v_add_u32 v71, v71, v70
    v_cvt_f32_u32 v71, v71
    v_fma_f32 v80, v64, v71, v69
    v_fma_f32 v84, v65, v71, v69
    v_fmamk_f32 v81, v66, 0x3f800000, v80
    v_fmamk_f32 v82, v66, 0x40000000, v80
    v_fmamk_f32 v83, v66, 0x40400000, v80
    v_fmamk_f32 v85, v67, 0x3f800000, v84
    v_fmamk_f32 v86, v67, 0x40000000, v84
    v_fmamk_f32 v87, v67, 0x40400000, v84
    v_sin_f32 v88, v80
    v_cos_f32 v80, v80
    v_sin_f32 v89, v81
    v_cos_f32 v81, v81
    v_sin_f32 v90, v82
    v_cos_f32 v82, v82
    v_sin_f32 v91, v83
    v_cos_f32 v83, v83
    v_sin_f32 v92, v84
    v_cos_f32 v84, v84
    v_sin_f32 v93, v85
    v_cos_f32 v85, v85
    v_sin_f32 v94, v86
    v_cos_f32 v86, v86
    v_sin_f32 v95, v87
    v_cos_f32 v87, v87
    v_cvt_pk_f16_f32 v48, v80, -v88
    v_cvt_pk_f16_f32 v49, v81, -v89
    v_cvt_pk_f16_f32 v50, v82, -v90
    v_cvt_pk_f16_f32 v51, v83, -v91
    v_cvt_pk_f16_f32 v52, v84, -v92
    v_cvt_pk_f16_f32 v53, v85, -v93
    v_cvt_pk_f16_f32 v54, v86, -v94
    v_cvt_pk_f16_f32 v55, v87, -v95
    s_cmp_lg_u32 s40, 0
    s_cbranch_scc1 LF_nofix
    s_xor_b64 s[56:57], s[46:47], s[54:55]
    v_cndmask_b32 v24, 0, v24, s[56:57]
    v_cndmask_b32 v25, 0, v25, s[56:57]
    v_cndmask_b32 v26, 0, v26, s[56:57]
    v_cndmask_b32 v27, 0, v27, s[56:57]
    v_cndmask_b32 v28, 0, v28, s[56:57]
    v_cndmask_b32 v29, 0, v29, s[56:57]
    v_cndmask_b32 v30, 0, v30, s[56:57]
    v_cndmask_b32 v31, 0, v31, s[56:57]
    v_lshlrev_b32 v71, 30, v2
    v_and_b32 v71, 0x80000000, v71
    v_or_b32 v71, 0x38003800, v71
    v_and_b32 v72, 0x31, v1
    v_cmp_eq_u32 vcc, 0, v72
    s_nop 1
    v_cndmask_b32 v24, v24, v71, vcc
    v_cndmask_b32 v28, v28, v71, vcc
LF_nofix:
    v_lshlrev_b32 v5, 7, v3
    v_and_b32 v64, 8, v1
    v_lshl_add_u32 v5, v64, 2, v5
    v_and_b32 v64, 1, v1
    v_lshl_add_u32 v5, v64, 4, v5
    v_and_b32 v64, 4, v1
    v_lshl_add_u32 v5, v64, 1, v5
    s_add_u32 s56, s50, 114688
    v_add_u32 v5, s56, v5
    v_mul_u32_u24 v6, 1040, v2
    v_lshl_add_u32 v6, v3, 7, v6
    s_lshl_b32 s56, s40, 4
    s_xor_b32 s57, s56, 32
    s_add_u32 s56, s56, 123008
    s_add_u32 s57, s57, 123008
    v_add_u32 v7, s57, v6
    v_add_u32 v6, s56, v6
    s_waitcnt vmcnt(5)
    ds_read_b64_tr_b16 v[96:97], v5 offset:0
    ds_read_b64_tr_b16 v[98:99], v5 offset:64
    ds_read_b64_tr_b16 v[100:101], v5 offset:512
    ds_read_b64_tr_b16 v[102:103], v5 offset:576
    ds_read_b64_tr_b16 v[104:105], v5 offset:1024
    ds_read_b64_tr_b16 v[106:107], v5 offset:1088
    ds_read_b64_tr_b16 v[108:109], v5 offset:1536
    ds_read_b64_tr_b16 v[110:111], v5 offset:1600
    v_cvt_f32_u32 v64, v2
    v_lshlrev_b32 v65, 2, v3
    v_cvt_f32_u32 v65, v65
    v_mul_f32 v66, 0x3d000000, v64
    v_add_f32 v67, 0.5, v66
    v_mul_f32 v80, v65, v66
    v_mul_f32 v84, v65, v67
    s_waitcnt lgkmcnt(6)
    v_mfma_f32_16x16x32_f16 v[112:115], v[24:27], v[96:99], 0
    v_mfma_f32_16x16x32_f16 v[116:119], v[28:31], v[96:99], 0
    s_waitcnt lgkmcnt(4)
    v_mfma_f32_16x16x32_f16 v[120:123], v[32:35], v[100:103], 0
    v_mfma_f32_16x16x32_f16 v[124:127], v[36:39], v[100:103], 0
    s_waitcnt lgkmcnt(2)
    v_mfma_f32_16x16x32_f16 v[128:131], v[40:43], v[104:107], 0
    v_mfma_f32_16x16x32_f16 v[132:135], v[44:47], v[104:107], 0
    s_waitcnt lgkmcnt(0)
    v_mfma_f32_16x16x32_f16 v[136:139], v[48:51], v[108:111], 0
    v_mfma_f32_16x16x32_f16 v[140:143], v[52:55], v[108:111], 0
    v_fmamk_f32 v81, v66, 0x3f800000, v80
    v_fmamk_f32 v82, v66, 0x40000000, v80
    v_fmamk_f32 v83, v66, 0x40400000, v80
    v_fmamk_f32 v85, v67, 0x3f800000, v84
    v_fmamk_f32 v86, v67, 0x40000000, v84
    v_fmamk_f32 v87, v67, 0x40400000, v84
    v_cvt_pk_f16_f32 v144, v112, v113
    v_cvt_pk_f16_f32 v145, v120, v121
    v_cvt_pk_f16_f32 v146, v128, v129
    v_cvt_pk_f16_f32 v147, v136, v137
    ds_write_b128 v6, v[144:147] offset:0
    v_cvt_pk_f16_f32 v148, v114, v115
    v_cvt_pk_f16_f32 v149, v122, v123
    v_cvt_pk_f16_f32 v150, v130, v131
    v_cvt_pk_f16_f32 v151, v138, v139
    ds_write_b128 v6, v[148:151] offset:64
    v_cvt_pk_f16_f32 v152, v116, v117
    v_cvt_pk_f16_f32 v153, v124, v125
    v_cvt_pk_f16_f32 v154, v132, v133
    v_cvt_pk_f16_f32 v155, v140, v141
    ds_write_b128 v7, v[152:155] offset:512
    v_cvt_pk_f16_f32 v156, v118, v119
    v_cvt_pk_f16_f32 v157, v126, v127
    v_cvt_pk_f16_f32 v158, v134, v135
    v_cvt_pk_f16_f32 v159, v142, v143
    ds_write_b128 v7, v[156:159] offset:576
    v_sin_f32 v88, v80
    v_cos_f32 v80, v80
    v_sin_f32 v89, v81
    v_cos_f32 v81, v81
    v_sin_f32 v90, v82
    v_cos_f32 v82, v82
    v_sin_f32 v91, v83
    v_cos_f32 v83, v83
    v_sin_f32 v92, v84
    v_cos_f32 v84, v84
    v_sin_f32 v93, v85
    v_cos_f32 v85, v85
    v_sin_f32 v94, v86
    v_cos_f32 v86, v86
    v_sin_f32 v95, v87
    v_cos_f32 v87, v87
    v_lshrrev_b32 v96, 3, v2
    v_lshlrev_b32 v96, 1, v96
    v_xor_b32 v96, v96, v3
    v_lshlrev_b32 v96, 4, v96
    v_lshl_add_u32 v8, v2, 6, v96
    s_mul_i32 s56, s40, 2080
    s_add_u32 s57, s56, 123008
    v_add_u32 v8, s57, v8
    s_waitcnt lgkmcnt(0)
    s_barrier
    ds_read_b128 v[96:99], v8 offset:0
    ds_read_b128 v[100:103], v8 offset:1040
    v_cvt_pk_f16_f32 v56, v80, -v88
    v_cvt_pk_f16_f32 v57, v81, -v89
    v_cvt_pk_f16_f32 v58, v82, -v90
    v_cvt_pk_f16_f32 v59, v83, -v91
    v_cvt_pk_f16_f32 v60, v84, -v92
    v_cvt_pk_f16_f32 v61, v85, -v93
    v_cvt_pk_f16_f32 v62, v86, -v94
    v_cvt_pk_f16_f32 v63, v87, -v95
    v_lshlrev_b32 v71, 31, v2
    v_or_b32 v71, 0x3c003c00, v71
    v_cmp_eq_u32 vcc, 0, v3
    s_nop 1
    v_cndmask_b32 v56, v56, v71, vcc
    v_cndmask_b32 v60, v60, v71, vcc
    s_waitcnt lgkmcnt(1)
    v_mfma_f32_16x16x32_f16 v[112:115], v[96:99], v[56:59], 0
    v_mfma_f32_16x16x32_f16 v[116:119], v[96:99], v[60:63], 0
    s_waitcnt lgkmcnt(0)
    v_mfma_f32_16x16x32_f16 v[120:123], v[100:103], v[56:59], 0
    v_mfma_f32_16x16x32_f16 v[124:127], v[100:103], v[60:63], 0
    s_waitcnt vmcnt(4)
    v_lshlrev_b32 v24, 16, v16
    v_and_b32 v25, 0xffff0000, v16
    v_lshlrev_b32 v26, 16, v17
    v_and_b32 v27, 0xffff0000, v17
    s_waitcnt vmcnt(3)
    v_lshlrev_b32 v28, 16, v18
    v_and_b32 v29, 0xffff0000, v18
    v_lshlrev_b32 v30, 16, v19
    v_and_b32 v31, 0xffff0000, v19
    s_waitcnt vmcnt(2)
    v_lshlrev_b32 v32, 16, v20
    v_and_b32 v33, 0xffff0000, v20
    v_lshlrev_b32 v34, 16, v21
    v_and_b32 v35, 0xffff0000, v21
    s_waitcnt vmcnt(1)
    v_lshlrev_b32 v36, 16, v22
    v_and_b32 v37, 0xffff0000, v22
    v_lshlrev_b32 v38, 16, v23
    v_and_b32 v39, 0xffff0000, v23
    s_lshl_b32 s57, s41, 17
    s_lshl_b32 s58, s43, 13
    s_add_u32 s57, s57, s58
    s_add_u32 s57, s57, s50
    s_add_u32 s57, s57, 6406144
    s_waitcnt vmcnt(0)
    v_readfirstlane_b32 s60, v15
    v_lshrrev_b32 v9, 1, v2
    v_lshlrev_b32 v9, 6, v9
    v_lshl_add_u32 v9, v3, 4, v9
    v_and_b32 v104, 1, v2
    v_lshl_add_u32 v9, v104, 3, v9
    s_add_u32 s56, s56, 114688
    v_add_u32 v9, s56, v9
    v_cvt_pk_bf16_f32 v112, v112, v113
    v_cvt_pk_bf16_f32 v114, v114, v115
    v_cvt_pk_bf16_f32 v116, v116, v117
    v_cvt_pk_bf16_f32 v118, v118, v119
    v_cvt_pk_bf16_f32 v120, v120, v121
    v_cvt_pk_bf16_f32 v122, v122, v123
    v_cvt_pk_bf16_f32 v124, v124, v125
    v_cvt_pk_bf16_f32 v126, v126, v127
    v_and_b32 v113, 0xffff0000, v112
    v_lshlrev_b32 v112, 16, v112
    v_and_b32 v115, 0xffff0000, v114
    v_lshlrev_b32 v114, 16, v114
    v_and_b32 v117, 0xffff0000, v116
    v_lshlrev_b32 v116, 16, v116
    v_and_b32 v119, 0xffff0000, v118
    v_lshlrev_b32 v118, 16, v118
    v_and_b32 v121, 0xffff0000, v120
    v_lshlrev_b32 v120, 16, v120
    v_and_b32 v123, 0xffff0000, v122
    v_lshlrev_b32 v122, 16, v122
    v_and_b32 v125, 0xffff0000, v124
    v_lshlrev_b32 v124, 16, v124
    v_and_b32 v127, 0xffff0000, v126
    v_lshlrev_b32 v126, 16, v126
    v_pk_fma_f32 v[112:113], v[112:113], s[60:61], v[24:25] op_sel_hi:[1,0,1]
    v_pk_fma_f32 v[114:115], v[114:115], s[60:61], v[26:27] op_sel_hi:[1,0,1]
    v_pk_fma_f32 v[116:117], v[116:117], s[60:61], v[28:29] op_sel_hi:[1,0,1]
    v_pk_fma_f32 v[118:119], v[118:119], s[60:61], v[30:31] op_sel_hi:[1,0,1]
    v_pk_fma_f32 v[120:121], v[120:121], s[60:61], v[32:33] op_sel_hi:[1,0,1]
    v_pk_fma_f32 v[122:123], v[122:123], s[60:61], v[34:35] op_sel_hi:[1,0,1]
    v_pk_fma_f32 v[124:125], v[124:125], s[60:61], v[36:37] op_sel_hi:[1,0,1]
    v_pk_fma_f32 v[126:127], v[126:127], s[60:61], v[38:39] op_sel_hi:[1,0,1]
    v_cvt_pk_bf16_f32 v16, v112, v113
    v_cvt_pk_bf16_f32 v17, v114, v115
    v_cvt_pk_bf16_f32 v18, v116, v117
    v_cvt_pk_bf16_f32 v19, v118, v119
    v_cvt_pk_bf16_f32 v20, v120, v121
    v_cvt_pk_bf16_f32 v21, v122, v123
    v_cvt_pk_bf16_f32 v22, v124, v125
    v_cvt_pk_bf16_f32 v23, v126, v127
    v_lshlrev_b32 v24, 16, v16
    v_and_b32 v25, 0xffff0000, v16
    v_lshlrev_b32 v26, 16, v17
    v_and_b32 v27, 0xffff0000, v17
    v_lshlrev_b32 v28, 16, v18
    v_and_b32 v29, 0xffff0000, v18
    v_lshlrev_b32 v30, 16, v19
    v_and_b32 v31, 0xffff0000, v19
    v_lshlrev_b32 v32, 16, v20
    v_and_b32 v33, 0xffff0000, v20
    v_lshlrev_b32 v34, 16, v21
    v_and_b32 v35, 0xffff0000, v21
    v_lshlrev_b32 v36, 16, v22
    v_and_b32 v37, 0xffff0000, v22
    v_lshlrev_b32 v38, 16, v23
    v_and_b32 v39, 0xffff0000, v23
    buffer_store_dwordx2 v[16:17], v13, s[20:23], s57 offen offset:0 sc1
    buffer_store_dwordx2 v[18:19], v13, s[20:23], s57 offen offset:512 sc1
    buffer_store_dwordx2 v[20:21], v13, s[20:23], s57 offen offset:1024 sc1
    buffer_store_dwordx2 v[22:23], v13, s[20:23], s57 offen offset:1536 sc1
    v_readfirstlane_b32 s84, v24
    v_readfirstlane_b32 s90, v32
    s_nop 0
    v_pk_add_f32 v[72:73], v[24:25], s[84:85] op_sel_hi:[1,0] neg_lo:[0,1] neg_hi:[0,1]
    v_pk_add_f32 v[74:75], v[26:27], s[84:85] op_sel_hi:[1,0] neg_lo:[0,1] neg_hi:[0,1]
    v_pk_add_f32 v[76:77], v[28:29], s[84:85] op_sel_hi:[1,0] neg_lo:[0,1] neg_hi:[0,1]
    v_pk_add_f32 v[78:79], v[30:31], s[84:85] op_sel_hi:[1,0] neg_lo:[0,1] neg_hi:[0,1]
    v_pk_add_f32 v[88:89], v[32:33], s[90:91] op_sel_hi:[1,0] neg_lo:[0,1] neg_hi:[0,1]
    v_pk_add_f32 v[90:91], v[34:35], s[90:91] op_sel_hi:[1,0] neg_lo:[0,1] neg_hi:[0,1]
    v_pk_add_f32 v[92:93], v[36:37], s[90:91] op_sel_hi:[1,0] neg_lo:[0,1] neg_hi:[0,1]
    v_pk_add_f32 v[94:95], v[38:39], s[90:91] op_sel_hi:[1,0] neg_lo:[0,1] neg_hi:[0,1]
    v_pk_add_f32 v[64:65], v[72:73], v[74:75]
    v_pk_mul_f32 v[66:67], v[72:73], v[72:73]
    v_pk_add_f32 v[70:71], v[76:77], v[78:79]
    v_pk_fma_f32 v[66:67], v[74:75], v[74:75], v[66:67]
    v_pk_add_f32 v[64:65], v[64:65], v[70:71]
    v_pk_fma_f32 v[66:67], v[76:77], v[76:77], v[66:67]
    v_add_f32 v64, v64, v65
    v_pk_fma_f32 v[66:67], v[78:79], v[78:79], v[66:67]
    v_add_f32 v66, v66, v67
    v_pk_add_f32 v[80:81], v[88:89], v[90:91]
    v_pk_mul_f32 v[82:83], v[88:89], v[88:89]
    v_pk_add_f32 v[86:87], v[92:93], v[94:95]
    v_pk_fma_f32 v[82:83], v[90:91], v[90:91], v[82:83]
    v_pk_add_f32 v[80:81], v[80:81], v[86:87]
    v_pk_fma_f32 v[82:83], v[92:93], v[92:93], v[82:83]
    v_add_f32 v80, v80, v81
    v_pk_fma_f32 v[82:83], v[94:95], v[94:95], v[82:83]
    v_add_f32 v82, v82, v83
    v_add_f32_dpp v64, v64, v64 row_shr:1 row_mask:0xf bank_mask:0xf bound_ctrl:0
    v_add_f32_dpp v66, v66, v66 row_shr:1 row_mask:0xf bank_mask:0xf bound_ctrl:0
    v_add_f32_dpp v80, v80, v80 row_shr:1 row_mask:0xf bank_mask:0xf bound_ctrl:0
    v_add_f32_dpp v82, v82, v82 row_shr:1 row_mask:0xf bank_mask:0xf bound_ctrl:0
    v_add_f32_dpp v64, v64, v64 row_shr:2 row_mask:0xf bank_mask:0xf bound_ctrl:0
    v_add_f32_dpp v66, v66, v66 row_shr:2 row_mask:0xf bank_mask:0xf bound_ctrl:0
    v_add_f32_dpp v80, v80, v80 row_shr:2 row_mask:0xf bank_mask:0xf bound_ctrl:0
    v_add_f32_dpp v82, v82, v82 row_shr:2 row_mask:0xf bank_mask:0xf bound_ctrl:0
    v_add_f32_dpp v64, v64, v64 row_shr:4 row_mask:0xf bank_mask:0xf bound_ctrl:0
    v_add_f32_dpp v66, v66, v66 row_shr:4 row_mask:0xf bank_mask:0xf bound_ctrl:0
    v_add_f32_dpp v80, v80, v80 row_shr:4 row_mask:0xf bank_mask:0xf bound_ctrl:0
    v_add_f32_dpp v82, v82, v82 row_shr:4 row_mask:0xf bank_mask:0xf bound_ctrl:0
    v_add_f32_dpp v64, v64, v64 row_shr:8 row_mask:0xf bank_mask:0xf bound_ctrl:0
    v_add_f32_dpp v66, v66, v66 row_shr:8 row_mask:0xf bank_mask:0xf bound_ctrl:0
    v_add_f32_dpp v80, v80, v80 row_shr:8 row_mask:0xf bank_mask:0xf bound_ctrl:0
    v_add_f32_dpp v82, v82, v82 row_shr:8 row_mask:0xf bank_mask:0xf bound_ctrl:0
    v_add_f32_dpp v64, v64, v64 row_bcast:15 row_mask:0xa bank_mask:0xf
    v_add_f32_dpp v66, v66, v66 row_bcast:15 row_mask:0xa bank_mask:0xf
    v_add_f32_dpp v80, v80, v80 row_bcast:15 row_mask:0xa bank_mask:0xf
    v_add_f32_dpp v82, v82, v82 row_bcast:15 row_mask:0xa bank_mask:0xf
    v_add_f32_dpp v64, v64, v64 row_bcast:31 row_mask:0xc bank_mask:0xf
    v_add_f32_dpp v66, v66, v66 row_bcast:31 row_mask:0xc bank_mask:0xf
    v_add_f32_dpp v80, v80, v80 row_bcast:31 row_mask:0xc bank_mask:0xf
    v_add_f32_dpp v82, v82, v82 row_bcast:31 row_mask:0xc bank_mask:0xf
    v_readlane_b32 s86, v64, 63
    v_readlane_b32 s88, v66, 63
    v_readlane_b32 s92, v80, 63
    v_readlane_b32 s94, v82, 63
    v_mov_b32 v70, 0x3b000000
    v_mov_b32 v86, 0x3b000000
    v_mul_f32 v64, s86, v70
    v_mul_f32 v66, s88, v70
    v_mul_f32 v80, s92, v86
    v_mul_f32 v82, s94, v86
    v_add_f32 v68, s84, v64
    v_fma_f32 v66, -v64, v64, v66
    v_add_f32 v84, s90, v80
    v_fma_f32 v82, -v80, v80, v82
    v_cvt_pk_bf16_f32 v68, v68, v68
    v_max_f32 v66, 0, v66
    v_cvt_pk_bf16_f32 v84, v84, v84
    v_max_f32 v82, 0, v82
    v_lshlrev_b32 v68, 16, v68
    v_cvt_pk_bf16_f32 v66, v66, v66
    v_lshlrev_b32 v84, 16, v84
    v_cvt_pk_bf16_f32 v82, v82, v82
    v_lshlrev_b32 v66, 16, v66
    v_pk_add_f32 v[72:73], v[24:25], v[68:69] op_sel_hi:[1,0] neg_lo:[0,1] neg_hi:[0,1]
    v_pk_add_f32 v[74:75], v[26:27], v[68:69] op_sel_hi:[1,0] neg_lo:[0,1] neg_hi:[0,1]
    v_lshlrev_b32 v82, 16, v82
    v_pk_add_f32 v[88:89], v[32:33], v[84:85] op_sel_hi:[1,0] neg_lo:[0,1] neg_hi:[0,1]
    v_pk_add_f32 v[90:91], v[34:35], v[84:85] op_sel_hi:[1,0] neg_lo:[0,1] neg_hi:[0,1]
    v_add_f32 v66, 0x3727c5ac, v66
    v_pk_add_f32 v[76:77], v[28:29], v[68:69] op_sel_hi:[1,0] neg_lo:[0,1] neg_hi:[0,1]
    v_pk_add_f32 v[78:79], v[30:31], v[68:69] op_sel_hi:[1,0] neg_lo:[0,1] neg_hi:[0,1]
    v_add_f32 v82, 0x3727c5ac, v82
    v_pk_add_f32 v[92:93], v[36:37], v[84:85] op_sel_hi:[1,0] neg_lo:[0,1] neg_hi:[0,1]
    v_pk_add_f32 v[94:95], v[38:39], v[84:85] op_sel_hi:[1,0] neg_lo:[0,1] neg_hi:[0,1]
    v_cvt_pk_bf16_f32 v66, v66, v66
    v_cvt_pk_bf16_f32 v72, v72, v73
    v_cvt_pk_bf16_f32 v74, v74, v75
    v_cvt_pk_bf16_f32 v82, v82, v82
    v_cvt_pk_bf16_f32 v88, v88, v89
    v_cvt_pk_bf16_f32 v90, v90, v91
    v_lshlrev_b32 v66, 16, v66
    v_cvt_pk_bf16_f32 v76, v76, v77
    v_cvt_pk_bf16_f32 v78, v78, v79
    v_lshlrev_b32 v82, 16, v82
    v_cvt_pk_bf16_f32 v92, v92, v93
    v_cvt_pk_bf16_f32 v94, v94, v95
    v_sqrt_f32 v66, v66
    v_and_b32 v73, 0xffff0000, v72
    v_lshlrev_b32 v72, 16, v72
    v_sqrt_f32 v82, v82
    v_and_b32 v89, 0xffff0000, v88
    v_lshlrev_b32 v88, 16, v88
    v_cvt_pk_bf16_f32 v66, v66, v66
    v_and_b32 v75, 0xffff0000, v74
    v_lshlrev_b32 v74, 16, v74
    v_cvt_pk_bf16_f32 v82, v82, v82
    v_and_b32 v91, 0xffff0000, v90
    v_lshlrev_b32 v90, 16, v90
    v_lshlrev_b32 v66, 16, v66
    v_and_b32 v77, 0xffff0000, v76
    v_lshlrev_b32 v76, 16, v76
    v_lshlrev_b32 v82, 16, v82
    v_and_b32 v93, 0xffff0000, v92
    v_lshlrev_b32 v92, 16, v92
    v_rcp_f32 v66, v66
    v_and_b32 v79, 0xffff0000, v78
    v_lshlrev_b32 v78, 16, v78
    v_rcp_f32 v82, v82
    v_and_b32 v95, 0xffff0000, v94
    v_lshlrev_b32 v94, 16, v94
    v_pk_mul_f32 v[72:73], v[72:73], v[66:67] op_sel_hi:[1,0]
    v_pk_mul_f32 v[74:75], v[74:75], v[66:67] op_sel_hi:[1,0]
    v_pk_mul_f32 v[76:77], v[76:77], v[66:67] op_sel_hi:[1,0]
    v_pk_mul_f32 v[78:79], v[78:79], v[66:67] op_sel_hi:[1,0]
    v_pk_mul_f32 v[88:89], v[88:89], v[82:83] op_sel_hi:[1,0]
    v_pk_mul_f32 v[90:91], v[90:91], v[82:83] op_sel_hi:[1,0]
    v_pk_mul_f32 v[92:93], v[92:93], v[82:83] op_sel_hi:[1,0]
    v_pk_mul_f32 v[94:95], v[94:95], v[82:83] op_sel_hi:[1,0]
    v_cvt_pk_bf16_f32 v40, v72, v73
    v_cvt_pk_bf16_f32 v41, v74, v75
    v_cvt_pk_bf16_f32 v42, v76, v77
    v_cvt_pk_bf16_f32 v43, v78, v79
    v_cvt_pk_bf16_f32 v44, v88, v89
    v_cvt_pk_bf16_f32 v45, v90, v91
    v_cvt_pk_bf16_f32 v46, v92, v93
    v_cvt_pk_bf16_f32 v47, v94, v95
    ds_write_b64 v9, v[40:41] offset:0
    ds_write_b64 v9, v[42:43] offset:512
    ds_write_b64 v9, v[44:45] offset:1040
    ds_write_b64 v9, v[46:47] offset:1552
    v_and_b32 v96, 7, v0
    v_mul_u32_u24 v10, 1040, v96
    v_lshrrev_b32 v97, 3, v0
    v_lshl_add_u32 v10, v97, 4, v10
    v_add_u32 v10, 114688, v10
    v_lshlrev_b32 v97, 8, v97
    v_lshl_add_u32 v97, v96, 4, v97
    s_lshl_b32 s56, s41, 17
    s_lshr_b32 s57, s43, 1
    s_lshl_b32 s57, s57, 14
    s_add_u32 s57, s57, s56
    s_and_b32 s58, s43, 1
    s_lshl_b32 s58, s58, 7
    s_add_u32 s57, s57, s58
    s_add_u32 s57, s57, 8503296
    s_add_u32 s58, s57, 8192
    s_waitcnt lgkmcnt(0)
    s_barrier
    ds_read_b128 v[100:103], v10 offset:0
    ds_read_b128 v[104:107], v10 offset:512
    s_waitcnt lgkmcnt(1)
    buffer_store_dwordx4 v[100:103], v97, s[20:23], s57 offen sc1
    s_waitcnt lgkmcnt(0)
    buffer_store_dwordx4 v[104:107], v97, s[20:23], s58 offen sc1
    s_lshl_b32 s44, s41, 9
    s_add_u32 s44, s44, 21610496
    s_lshr_b32 s45, s43, 2
    s_lshl_b32 s45, s45, 7
    s_add_u32 s45, s45, s44
    s_and_b32 s46, s43, 3
    s_lshl_b32 s46, s46, 2
    s_add_u32 s45, s45, s46
    s_lshl_b32 s46, s40, 7
    s_add_u32 s44, s44, s46
    s_lshl_b32 s46, s41, 10
    s_add_u32 s46, s46, 21618688
    s_lshr_b32 s47, s43, 1
    s_lshl_b32 s47, s47, 7
    s_add_u32 s47, s47, s46
    s_and_b32 s53, s43, 1
    s_lshl_b32 s53, s53, 2
    s_add_u32 s47, s47, s53
    s_xor_b32 s53, s40, 4
    s_lshl_b32 s53, s53, 7
    s_add_u32 s46, s46, s53
    s_lshl_b32 s55, s40, 15
    s_add_u32 s55, s55, s56
    s_add_u32 s55, s55, 8503296
    v_add_u32 v6, 64512, v14
    s_waitcnt vmcnt(0)
    s_barrier
    s_cmp_lg_u32 s40, 0
    s_cbranch_scc1 LF1_nopub
    v_mov_b32 v240, 1
    v_mov_b32 v241, 0
    s_mov_b64 exec, 1
    buffer_store_dword v240, v241, s[20:23], s45 offen sc1
    s_mov_b64 exec, -1
LF1_nopub:
    s_barrier
    ds_read_b128 v[104:107], v14 offset:0
    ds_read_b128 v[108:111], v14 offset:1024
    ds_read_b128 v[112:115], v14 offset:2048
    ds_read_b128 v[116:119], v14 offset:3072
    ds_read_b128 v[120:123], v14 offset:4096
    ds_read_b128 v[124:127], v14 offset:5120
    ds_read_b128 v[128:131], v14 offset:6144
    s_waitcnt lgkmcnt(0)
    v_and_b32 v242, 3, v1
    v_lshlrev_b32 v242, 2, v242
    s_mov_b32 s58, 200000
    buffer_load_dword v243, v242, s[20:23], s44 offen sc1
    buffer_load_dword v244, v242, s[20:23], s44 offen sc1
LF1_poll:
    s_waitcnt vmcnt(1)
    v_cmp_eq_u32 vcc, 1, v243
    buffer_load_dword v243, v242, s[20:23], s44 offen sc1
    s_nop 2
    s_cmp_eq_u64 vcc, exec
    s_cbranch_scc1 LF1_join
    s_waitcnt vmcnt(1)
    v_cmp_eq_u32 vcc, 1, v244
    buffer_load_dword v244, v242, s[20:23], s44 offen sc1
    s_nop 2
    s_cmp_eq_u64 vcc, exec
    s_cbranch_scc1 LF1_join
    s_sub_u32 s58, s58, 1
    s_cmp_lg_u32 s58, 0
    s_cbranch_scc1 LF1_poll
LF1_join:
    s_nop 1
    s_add_u32 s48, s55, 0
    buffer_load_dwordx4 v[16:19], v14, s[20:23], s48 offen offset:0 sc1
    s_add_u32 s49, s55, 16384
    buffer_load_dwordx4 v[20:23], v14, s[20:23], s49 offen offset:0 sc1
    buffer_load_dwordx4 v[24:27], v14, s[20:23], s48 offen offset:1024 sc1
    buffer_load_dwordx4 v[28:31], v14, s[20:23], s49 offen offset:1024 sc1
    buffer_load_dwordx4 v[32:35], v14, s[20:23], s48 offen offset:2048 sc1
    buffer_load_dwordx4 v[36:39], v14, s[20:23], s49 offen offset:2048 sc1
    buffer_load_dwordx4 v[40:43], v14, s[20:23], s48 offen offset:3072 sc1
    buffer_load_dwordx4 v[44:47], v14, s[20:23], s49 offen offset:3072 sc1
    s_lshl_b32 s50, s41, 3
    s_lshl_b32 s51, s40, 1
    s_add_u32 s50, s50, s51
    s_mul_i32 s50, s50, 57344
    s_lshr_b32 s51, s43, 1
    s_mul_i32 s51, s51, 7168
    s_add_u32 s50, s50, s51
    s_add_u32 s50, s50, 12435456
    s_and_b32 s51, s43, 1
    s_mul_i32 s52, s51, 3072
    s_add_u32 s52, s52, s50
    s_lshl_b32 s51, s51, 9
    s_add_u32 s51, s51, s50
    s_add_u32 s51, s51, 6144
    v_lshlrev_b32 v7, 3, v1
    s_add_u32 s53, s52, 57344
    s_add_u32 s54, s51, 57344
    s_mov_b32 s56, 0xbfb8aa3b
    s_waitcnt vmcnt(7)
    v_mfma_f32_16x16x32_bf16 v[160:163], v[104:107], v[16:19], 0
    ds_read_b128 v[132:135], v14 offset:7168
    s_waitcnt vmcnt(6)
    v_mfma_f32_16x16x32_bf16 v[188:191], v[104:107], v[20:23], 0
    v_mfma_f32_16x16x32_bf16 v[164:167], v[108:111], v[16:19], 0
    ds_read_b128 v[136:139], v14 offset:8192
    v_mfma_f32_16x16x32_bf16 v[192:195], v[108:111], v[20:23], 0
    s_add_u32 s48, s55, 4096
    buffer_load_dwordx4 v[48:51], v14, s[20:23], s48 offen offset:0 sc1
    v_mfma_f32_16x16x32_bf16 v[168:171], v[112:115], v[16:19], 0
    ds_read_b128 v[140:143], v14 offset:9216
    v_mfma_f32_16x16x32_bf16 v[196:199], v[112:115], v[20:23], 0
    v_mfma_f32_16x16x32_bf16 v[172:175], v[116:119], v[16:19], 0
    ds_read_b128 v[144:147], v14 offset:10240
    v_mfma_f32_16x16x32_bf16 v[200:203], v[116:119], v[20:23], 0
    s_add_u32 s49, s55, 20480
    buffer_load_dwordx4 v[52:55], v14, s[20:23], s49 offen offset:0 sc1
    v_mfma_f32_16x16x32_bf16 v[176:179], v[120:123], v[16:19], 0
    ds_read_b128 v[148:151], v14 offset:11264
    v_mfma_f32_16x16x32_bf16 v[204:207], v[120:123], v[20:23], 0
    v_mfma_f32_16x16x32_bf16 v[180:183], v[124:127], v[16:19], 0
    ds_read_b128 v[152:155], v14 offset:12288
    v_mfma_f32_16x16x32_bf16 v[208:211], v[124:127], v[20:23], 0
    v_mfma_f32_16x16x32_bf16 v[184:187], v[128:131], v[16:19], 0
    ds_read_b128 v[156:159], v14 offset:13312
    v_mfma_f32_16x16x32_bf16 v[212:215], v[128:131], v[20:23], 0
    s_waitcnt vmcnt(7) lgkmcnt(6)
    v_mfma_f32_16x16x32_bf16 v[160:163], v[132:135], v[24:27], v[160:163]
    ds_read_b128 v[104:107], v14 offset:14336
    s_waitcnt vmcnt(6)
    v_mfma_f32_16x16x32_bf16 v[188:191], v[132:135], v[28:31], v[188:191]
    s_waitcnt lgkmcnt(6)
    v_mfma_f32_16x16x32_bf16 v[164:167], v[136:139], v[24:27], v[164:167]
    ds_read_b128 v[108:111], v14 offset:15360
    v_mfma_f32_16x16x32_bf16 v[192:195], v[136:139], v[28:31], v[192:195]
    buffer_load_dwordx4 v[56:59], v14, s[20:23], s48 offen offset:1024 sc1
    s_waitcnt lgkmcnt(6)
    v_mfma_f32_16x16x32_bf16 v[168:171], v[140:143], v[24:27], v[168:171]
    ds_read_b128 v[112:115], v14 offset:16384
    v_mfma_f32_16x16x32_bf16 v[196:199], v[140:143], v[28:31], v[196:199]
    s_waitcnt lgkmcnt(6)
    v_mfma_f32_16x16x32_bf16 v[172:175], v[144:147], v[24:27], v[172:175]
    ds_read_b128 v[116:119], v14 offset:17408
    v_mfma_f32_16x16x32_bf16 v[200:203], v[144:147], v[28:31], v[200:203]
    buffer_load_dwordx4 v[60:63], v14, s[20:23], s49 offen offset:1024 sc1
    s_waitcnt lgkmcnt(6)
    v_mfma_f32_16x16x32_bf16 v[176:179], v[148:151], v[24:27], v[176:179]
    ds_read_b128 v[120:123], v14 offset:18432
    v_mfma_f32_16x16x32_bf16 v[204:207], v[148:151], v[28:31], v[204:207]
    s_waitcnt lgkmcnt(6)
    v_mfma_f32_16x16x32_bf16 v[180:183], v[152:155], v[24:27], v[180:183]
    ds_read_b128 v[124:127], v14 offset:19456
    v_mfma_f32_16x16x32_bf16 v[208:211], v[152:155], v[28:31], v[208:211]
    s_waitcnt lgkmcnt(6)
    v_mfma_f32_16x16x32_bf16 v[184:187], v[156:159], v[24:27], v[184:187]
    ds_read_b128 v[128:131], v14 offset:20480
    v_mfma_f32_16x16x32_bf16 v[212:215], v[156:159], v[28:31], v[212:215]
    s_waitcnt vmcnt(7) lgkmcnt(6)
    v_mfma_f32_16x16x32_bf16 v[160:163], v[104:107], v[32:35], v[160:163]
    ds_read_b128 v[132:135], v14 offset:21504
    s_waitcnt vmcnt(6)
    v_mfma_f32_16x16x32_bf16 v[188:191], v[104:107], v[36:39], v[188:191]
    s_waitcnt lgkmcnt(6)
    v_mfma_f32_16x16x32_bf16 v[164:167], v[108:111], v[32:35], v[164:167]
    ds_read_b128 v[136:139], v14 offset:22528
    v_mfma_f32_16x16x32_bf16 v[192:195], v[108:111], v[36:39], v[192:195]
    buffer_load_dwordx4 v[16:19], v14, s[20:23], s48 offen offset:2048 sc1
    s_waitcnt lgkmcnt(6)
    v_mfma_f32_16x16x32_bf16 v[168:171], v[112:115], v[32:35], v[168:171]
    ds_read_b128 v[140:143], v14 offset:23552
    v_mfma_f32_16x16x32_bf16 v[196:199], v[112:115], v[36:39], v[196:199]
    s_waitcnt lgkmcnt(6)
    v_mfma_f32_16x16x32_bf16 v[172:175], v[116:119], v[32:35], v[172:175]
    ds_read_b128 v[144:147], v14 offset:24576
    v_mfma_f32_16x16x32_bf16 v[200:203], v[116:119], v[36:39], v[200:203]
    buffer_load_dwordx4 v[20:23], v14, s[20:23], s49 offen offset:2048 sc1
    s_waitcnt lgkmcnt(6)
    v_mfma_f32_16x16x32_bf16 v[176:179], v[120:123], v[32:35], v[176:179]
    ds_read_b128 v[148:151], v14 offset:25600
    v_mfma_f32_16x16x32_bf16 v[204:207], v[120:123], v[36:39], v[204:207]
    s_waitcnt lgkmcnt(6)
    v_mfma_f32_16x16x32_bf16 v[180:183], v[124:127], v[32:35], v[180:183]
    ds_read_b128 v[152:155], v14 offset:26624
    v_mfma_f32_16x16x32_bf16 v[208:211], v[124:127], v[36:39], v[208:211]
    s_waitcnt lgkmcnt(6)
    v_mfma_f32_16x16x32_bf16 v[184:187], v[128:131], v[32:35], v[184:187]
    ds_read_b128 v[156:159], v14 offset:27648
    v_mfma_f32_16x16x32_bf16 v[212:215], v[128:131], v[36:39], v[212:215]
    s_waitcnt vmcnt(7) lgkmcnt(6)
    v_mfma_f32_16x16x32_bf16 v[160:163], v[132:135], v[40:43], v[160:163]
    ds_read_b128 v[104:107], v14 offset:28672
    s_waitcnt vmcnt(6)
    v_mfma_f32_16x16x32_bf16 v[188:191], v[132:135], v[44:47], v[188:191]
    s_waitcnt lgkmcnt(6)
    v_mfma_f32_16x16x32_bf16 v[164:167], v[136:139], v[40:43], v[164:167]
    ds_read_b128 v[108:111], v14 offset:29696
    v_mfma_f32_16x16x32_bf16 v[192:195], v[136:139], v[44:47], v[192:195]
    buffer_load_dwordx4 v[24:27], v14, s[20:23], s48 offen offset:3072 sc1
    s_waitcnt lgkmcnt(6)
    v_mfma_f32_16x16x32_bf16 v[168:171], v[140:143], v[40:43], v[168:171]
    ds_read_b128 v[112:115], v14 offset:30720
    v_mfma_f32_16x16x32_bf16 v[196:199], v[140:143], v[44:47], v[196:199]
    s_waitcnt lgkmcnt(6)
    v_mfma_f32_16x16x32_bf16 v[172:175], v[144:147], v[40:43], v[172:175]
    ds_read_b128 v[116:119], v14 offset:31744
    v_mfma_f32_16x16x32_bf16 v[200:203], v[144:147], v[44:47], v[200:203]
    buffer_load_dwordx4 v[28:31], v14, s[20:23], s49 offen offset:3072 sc1
    s_waitcnt lgkmcnt(6)
    v_mfma_f32_16x16x32_bf16 v[176:179], v[148:151], v[40:43], v[176:179]
    ds_read_b128 v[120:123], v14 offset:32768
    v_mfma_f32_16x16x32_bf16 v[204:207], v[148:151], v[44:47], v[204:207]
    s_waitcnt lgkmcnt(6)
    v_mfma_f32_16x16x32_bf16 v[180:183], v[152:155], v[40:43], v[180:183]
    ds_read_b128 v[124:127], v14 offset:33792
    v_mfma_f32_16x16x32_bf16 v[208:211], v[152:155], v[44:47], v[208:211]
    s_waitcnt lgkmcnt(6)
    v_mfma_f32_16x16x32_bf16 v[184:187], v[156:159], v[40:43], v[184:187]
    ds_read_b128 v[128:131], v14 offset:34816
    v_mfma_f32_16x16x32_bf16 v[212:215], v[156:159], v[44:47], v[212:215]
    s_waitcnt vmcnt(7) lgkmcnt(6)
    v_mfma_f32_16x16x32_bf16 v[160:163], v[104:107], v[48:51], v[160:163]
    ds_read_b128 v[132:135], v14 offset:35840
    s_waitcnt vmcnt(6)
    v_mfma_f32_16x16x32_bf16 v[188:191], v[104:107], v[52:55], v[188:191]
    s_waitcnt lgkmcnt(6)
    v_mfma_f32_16x16x32_bf16 v[164:167], v[108:111], v[48:51], v[164:167]
    ds_read_b128 v[136:139], v14 offset:36864
    v_mfma_f32_16x16x32_bf16 v[192:195], v[108:111], v[52:55], v[192:195]
    s_add_u32 s48, s55, 8192
    buffer_load_dwordx4 v[32:35], v14, s[20:23], s48 offen offset:0 sc1
    s_waitcnt lgkmcnt(6)
    v_mfma_f32_16x16x32_bf16 v[168:171], v[112:115], v[48:51], v[168:171]
    ds_read_b128 v[140:143], v14 offset:37888
    v_mfma_f32_16x16x32_bf16 v[196:199], v[112:115], v[52:55], v[196:199]
    s_waitcnt lgkmcnt(6)
    v_mfma_f32_16x16x32_bf16 v[172:175], v[116:119], v[48:51], v[172:175]
    ds_read_b128 v[144:147], v14 offset:38912
    v_mfma_f32_16x16x32_bf16 v[200:203], v[116:119], v[52:55], v[200:203]
    s_add_u32 s49, s55, 24576
    buffer_load_dwordx4 v[36:39], v14, s[20:23], s49 offen offset:0 sc1
    s_waitcnt lgkmcnt(6)
    v_mfma_f32_16x16x32_bf16 v[176:179], v[120:123], v[48:51], v[176:179]
    ds_read_b128 v[148:151], v14 offset:39936
    v_mfma_f32_16x16x32_bf16 v[204:207], v[120:123], v[52:55], v[204:207]
    s_waitcnt lgkmcnt(6)
    v_mfma_f32_16x16x32_bf16 v[180:183], v[124:127], v[48:51], v[180:183]
    ds_read_b128 v[152:155], v14 offset:40960
    v_mfma_f32_16x16x32_bf16 v[208:211], v[124:127], v[52:55], v[208:211]
    s_waitcnt lgkmcnt(6)
    v_mfma_f32_16x16x32_bf16 v[184:187], v[128:131], v[48:51], v[184:187]
    ds_read_b128 v[156:159], v14 offset:41984
    v_mfma_f32_16x16x32_bf16 v[212:215], v[128:131], v[52:55], v[212:215]
    s_waitcnt vmcnt(7) lgkmcnt(6)
    v_mfma_f32_16x16x32_bf16 v[160:163], v[132:135], v[56:59], v[160:163]
    ds_read_b128 v[104:107], v14 offset:43008
    s_waitcnt vmcnt(6)
    v_mfma_f32_16x16x32_bf16 v[188:191], v[132:135], v[60:63], v[188:191]
    s_waitcnt lgkmcnt(6)
    v_mfma_f32_16x16x32_bf16 v[164:167], v[136:139], v[56:59], v[164:167]
    ds_read_b128 v[108:111], v14 offset:44032
    v_mfma_f32_16x16x32_bf16 v[192:195], v[136:139], v[60:63], v[192:195]
    buffer_load_dwordx4 v[40:43], v14, s[20:23], s48 offen offset:1024 sc1
    s_waitcnt lgkmcnt(6)
    v_mfma_f32_16x16x32_bf16 v[168:171], v[140:143], v[56:59], v[168:171]
    ds_read_b128 v[112:115], v14 offset:45056
    v_mfma_f32_16x16x32_bf16 v[196:199], v[140:143], v[60:63], v[196:199]
    s_waitcnt lgkmcnt(6)
    v_mfma_f32_16x16x32_bf16 v[172:175], v[144:147], v[56:59], v[172:175]
    ds_read_b128 v[116:119], v14 offset:46080
    v_mfma_f32_16x16x32_bf16 v[200:203], v[144:147], v[60:63], v[200:203]
    buffer_load_dwordx4 v[44:47], v14, s[20:23], s49 offen offset:1024 sc1
    s_waitcnt lgkmcnt(6)
    v_mfma_f32_16x16x32_bf16 v[176:179], v[148:151], v[56:59], v[176:179]
    ds_read_b128 v[120:123], v14 offset:47104
    v_mfma_f32_16x16x32_bf16 v[204:207], v[148:151], v[60:63], v[204:207]
    s_waitcnt lgkmcnt(6)
    v_mfma_f32_16x16x32_bf16 v[180:183], v[152:155], v[56:59], v[180:183]
    ds_read_b128 v[124:127], v14 offset:48128
    v_mfma_f32_16x16x32_bf16 v[208:211], v[152:155], v[60:63], v[208:211]
    s_waitcnt lgkmcnt(6)
    v_mfma_f32_16x16x32_bf16 v[184:187], v[156:159], v[56:59], v[184:187]
    ds_read_b128 v[128:131], v14 offset:49152
    v_mfma_f32_16x16x32_bf16 v[212:215], v[156:159], v[60:63], v[212:215]
    s_waitcnt vmcnt(7) lgkmcnt(6)
    v_mfma_f32_16x16x32_bf16 v[160:163], v[104:107], v[16:19], v[160:163]
    ds_read_b128 v[132:135], v14 offset:50176
    s_waitcnt vmcnt(6)
    v_mfma_f32_16x16x32_bf16 v[188:191], v[104:107], v[20:23], v[188:191]
    s_waitcnt lgkmcnt(6)
    v_mfma_f32_16x16x32_bf16 v[164:167], v[108:111], v[16:19], v[164:167]
    ds_read_b128 v[136:139], v14 offset:51200
    v_mfma_f32_16x16x32_bf16 v[192:195], v[108:111], v[20:23], v[192:195]
    buffer_load_dwordx4 v[48:51], v14, s[20:23], s48 offen offset:2048 sc1
    s_waitcnt lgkmcnt(6)
    v_mfma_f32_16x16x32_bf16 v[168:171], v[112:115], v[16:19], v[168:171]
    ds_read_b128 v[140:143], v14 offset:52224
    v_mfma_f32_16x16x32_bf16 v[196:199], v[112:115], v[20:23], v[196:199]
    s_waitcnt lgkmcnt(6)
    v_mfma_f32_16x16x32_bf16 v[172:175], v[116:119], v[16:19], v[172:175]
    ds_read_b128 v[144:147], v14 offset:53248
    v_mfma_f32_16x16x32_bf16 v[200:203], v[116:119], v[20:23], v[200:203]
    buffer_load_dwordx4 v[52:55], v14, s[20:23], s49 offen offset:2048 sc1
    s_waitcnt lgkmcnt(6)
    v_mfma_f32_16x16x32_bf16 v[176:179], v[120:123], v[16:19], v[176:179]
    ds_read_b128 v[148:151], v14 offset:54272
    v_mfma_f32_16x16x32_bf16 v[204:207], v[120:123], v[20:23], v[204:207]
    s_waitcnt lgkmcnt(6)
    v_mfma_f32_16x16x32_bf16 v[180:183], v[124:127], v[16:19], v[180:183]
    ds_read_b128 v[152:155], v14 offset:55296
    v_mfma_f32_16x16x32_bf16 v[208:211], v[124:127], v[20:23], v[208:211]
    s_waitcnt lgkmcnt(6)
    v_mfma_f32_16x16x32_bf16 v[184:187], v[128:131], v[16:19], v[184:187]
    ds_read_b128 v[156:159], v14 offset:56320
    v_mfma_f32_16x16x32_bf16 v[212:215], v[128:131], v[20:23], v[212:215]
    s_waitcnt vmcnt(7) lgkmcnt(6)
    v_mfma_f32_16x16x32_bf16 v[160:163], v[132:135], v[24:27], v[160:163]
    ds_read_b128 v[104:107], v14 offset:57344
    s_waitcnt vmcnt(6)
    v_mfma_f32_16x16x32_bf16 v[188:191], v[132:135], v[28:31], v[188:191]
    s_waitcnt lgkmcnt(6)
    v_mfma_f32_16x16x32_bf16 v[164:167], v[136:139], v[24:27], v[164:167]
    ds_read_b128 v[108:111], v14 offset:58368
    v_mfma_f32_16x16x32_bf16 v[192:195], v[136:139], v[28:31], v[192:195]
    buffer_load_dwordx4 v[56:59], v14, s[20:23], s48 offen offset:3072 sc1
    s_waitcnt lgkmcnt(6)
    v_mfma_f32_16x16x32_bf16 v[168:171], v[140:143], v[24:27], v[168:171]
    ds_read_b128 v[112:115], v14 offset:59392
    v_mfma_f32_16x16x32_bf16 v[196:199], v[140:143], v[28:31], v[196:199]
    s_waitcnt lgkmcnt(6)
    v_mfma_f32_16x16x32_bf16 v[172:175], v[144:147], v[24:27], v[172:175]
    ds_read_b128 v[116:119], v14 offset:60416
    v_mfma_f32_16x16x32_bf16 v[200:203], v[144:147], v[28:31], v[200:203]
    buffer_load_dwordx4 v[60:63], v14, s[20:23], s49 offen offset:3072 sc1
    s_waitcnt lgkmcnt(6)
    v_mfma_f32_16x16x32_bf16 v[176:179], v[148:151], v[24:27], v[176:179]
    ds_read_b128 v[120:123], v14 offset:61440
    v_mfma_f32_16x16x32_bf16 v[204:207], v[148:151], v[28:31], v[204:207]
    s_waitcnt lgkmcnt(6)
    v_mfma_f32_16x16x32_bf16 v[180:183], v[152:155], v[24:27], v[180:183]
    ds_read_b128 v[124:127], v14 offset:62464
    v_mfma_f32_16x16x32_bf16 v[208:211], v[152:155], v[28:31], v[208:211]
    s_waitcnt lgkmcnt(6)
    v_mfma_f32_16x16x32_bf16 v[184:187], v[156:159], v[24:27], v[184:187]
    ds_read_b128 v[128:131], v14 offset:63488
    v_mfma_f32_16x16x32_bf16 v[212:215], v[156:159], v[28:31], v[212:215]
    s_waitcnt vmcnt(7) lgkmcnt(6)
    v_mfma_f32_16x16x32_bf16 v[160:163], v[104:107], v[32:35], v[160:163]
    ds_read_b128 v[132:135], v6 offset:0
    s_waitcnt vmcnt(6)
    v_mfma_f32_16x16x32_bf16 v[188:191], v[104:107], v[36:39], v[188:191]
    s_waitcnt lgkmcnt(6)
    v_mfma_f32_16x16x32_bf16 v[164:167], v[108:111], v[32:35], v[164:167]
    ds_read_b128 v[136:139], v6 offset:1024
    v_mfma_f32_16x16x32_bf16 v[192:195], v[108:111], v[36:39], v[192:195]
    s_add_u32 s48, s55, 12288
    buffer_load_dwordx4 v[16:19], v14, s[20:23], s48 offen offset:0 sc1
    s_waitcnt lgkmcnt(6)
    v_mfma_f32_16x16x32_bf16 v[168:171], v[112:115], v[32:35], v[168:171]
    ds_read_b128 v[140:143], v6 offset:2048
    v_mfma_f32_16x16x32_bf16 v[196:199], v[112:115], v[36:39], v[196:199]
    s_waitcnt lgkmcnt(6)
    v_mfma_f32_16x16x32_bf16 v[172:175], v[116:119], v[32:35], v[172:175]
    ds_read_b128 v[144:147], v6 offset:3072
    v_mfma_f32_16x16x32_bf16 v[200:203], v[116:119], v[36:39], v[200:203]
    s_add_u32 s49, s55, 28672
    buffer_load_dwordx4 v[20:23], v14, s[20:23], s49 offen offset:0 sc1
    s_waitcnt lgkmcnt(6)
    v_mfma_f32_16x16x32_bf16 v[176:179], v[120:123], v[32:35], v[176:179]
    ds_read_b128 v[148:151], v6 offset:4096
    v_mfma_f32_16x16x32_bf16 v[204:207], v[120:123], v[36:39], v[204:207]
    s_waitcnt lgkmcnt(6)
    v_mfma_f32_16x16x32_bf16 v[180:183], v[124:127], v[32:35], v[180:183]
    ds_read_b128 v[152:155], v6 offset:5120
    v_mfma_f32_16x16x32_bf16 v[208:211], v[124:127], v[36:39], v[208:211]
    s_waitcnt lgkmcnt(6)
    v_mfma_f32_16x16x32_bf16 v[184:187], v[128:131], v[32:35], v[184:187]
    ds_read_b128 v[156:159], v6 offset:6144
    v_mfma_f32_16x16x32_bf16 v[212:215], v[128:131], v[36:39], v[212:215]
    s_waitcnt vmcnt(7) lgkmcnt(6)
    v_mfma_f32_16x16x32_bf16 v[160:163], v[132:135], v[40:43], v[160:163]
    ds_read_b128 v[104:107], v6 offset:7168
    s_waitcnt vmcnt(6)
    v_mfma_f32_16x16x32_bf16 v[188:191], v[132:135], v[44:47], v[188:191]
    s_waitcnt lgkmcnt(6)
    v_mfma_f32_16x16x32_bf16 v[164:167], v[136:139], v[40:43], v[164:167]
    ds_read_b128 v[108:111], v6 offset:8192
    v_mfma_f32_16x16x32_bf16 v[192:195], v[136:139], v[44:47], v[192:195]
    buffer_load_dwordx4 v[24:27], v14, s[20:23], s48 offen offset:1024 sc1
    s_waitcnt lgkmcnt(6)
    v_mfma_f32_16x16x32_bf16 v[168:171], v[140:143], v[40:43], v[168:171]
    ds_read_b128 v[112:115], v6 offset:9216
    v_mfma_f32_16x16x32_bf16 v[196:199], v[140:143], v[44:47], v[196:199]
    s_waitcnt lgkmcnt(6)
    v_mfma_f32_16x16x32_bf16 v[172:175], v[144:147], v[40:43], v[172:175]
    ds_read_b128 v[116:119], v6 offset:10240
    v_mfma_f32_16x16x32_bf16 v[200:203], v[144:147], v[44:47], v[200:203]
    buffer_load_dwordx4 v[28:31], v14, s[20:23], s49 offen offset:1024 sc1
    s_waitcnt lgkmcnt(6)
    v_mfma_f32_16x16x32_bf16 v[176:179], v[148:151], v[40:43], v[176:179]
    ds_read_b128 v[120:123], v6 offset:11264
    v_mfma_f32_16x16x32_bf16 v[204:207], v[148:151], v[44:47], v[204:207]
    s_waitcnt lgkmcnt(6)
    v_mfma_f32_16x16x32_bf16 v[180:183], v[152:155], v[40:43], v[180:183]
    ds_read_b128 v[124:127], v6 offset:12288
    v_mfma_f32_16x16x32_bf16 v[208:211], v[152:155], v[44:47], v[208:211]
    s_waitcnt lgkmcnt(6)
    v_mfma_f32_16x16x32_bf16 v[184:187], v[156:159], v[40:43], v[184:187]
    ds_read_b128 v[128:131], v6 offset:13312
    v_mfma_f32_16x16x32_bf16 v[212:215], v[156:159], v[44:47], v[212:215]
    s_waitcnt vmcnt(7) lgkmcnt(6)
    v_mfma_f32_16x16x32_bf16 v[160:163], v[104:107], v[48:51], v[160:163]
    ds_read_b128 v[132:135], v6 offset:14336
    s_waitcnt vmcnt(6)
    v_mfma_f32_16x16x32_bf16 v[188:191], v[104:107], v[52:55], v[188:191]
    s_waitcnt lgkmcnt(6)
    v_mfma_f32_16x16x32_bf16 v[164:167], v[108:111], v[48:51], v[164:167]
    ds_read_b128 v[136:139], v6 offset:15360
    v_mfma_f32_16x16x32_bf16 v[192:195], v[108:111], v[52:55], v[192:195]
    buffer_load_dwordx4 v[32:35], v14, s[20:23], s48 offen offset:2048 sc1
    s_waitcnt lgkmcnt(6)
    v_mfma_f32_16x16x32_bf16 v[168:171], v[112:115], v[48:51], v[168:171]
    ds_read_b128 v[140:143], v6 offset:16384
    v_mfma_f32_16x16x32_bf16 v[196:199], v[112:115], v[52:55], v[196:199]
    s_waitcnt lgkmcnt(6)
    v_mfma_f32_16x16x32_bf16 v[172:175], v[116:119], v[48:51], v[172:175]
    ds_read_b128 v[144:147], v6 offset:17408
    v_mfma_f32_16x16x32_bf16 v[200:203], v[116:119], v[52:55], v[200:203]
    buffer_load_dwordx4 v[36:39], v14, s[20:23], s49 offen offset:2048 sc1
    s_waitcnt lgkmcnt(6)
    v_mfma_f32_16x16x32_bf16 v[176:179], v[120:123], v[48:51], v[176:179]
    ds_read_b128 v[148:151], v6 offset:18432
    v_mfma_f32_16x16x32_bf16 v[204:207], v[120:123], v[52:55], v[204:207]
    s_waitcnt lgkmcnt(6)
    v_mfma_f32_16x16x32_bf16 v[180:183], v[124:127], v[48:51], v[180:183]
    ds_read_b128 v[152:155], v6 offset:19456
    v_mfma_f32_16x16x32_bf16 v[208:211], v[124:127], v[52:55], v[208:211]
    s_waitcnt lgkmcnt(6)
    v_mfma_f32_16x16x32_bf16 v[184:187], v[128:131], v[48:51], v[184:187]
    ds_read_b128 v[156:159], v6 offset:20480
    v_mfma_f32_16x16x32_bf16 v[212:215], v[128:131], v[52:55], v[212:215]
    s_waitcnt vmcnt(7) lgkmcnt(6)
    v_mfma_f32_16x16x32_bf16 v[160:163], v[132:135], v[56:59], v[160:163]
    ds_read_b128 v[104:107], v6 offset:21504
    s_waitcnt vmcnt(6)
    v_mfma_f32_16x16x32_bf16 v[188:191], v[132:135], v[60:63], v[188:191]
    s_waitcnt lgkmcnt(6)
    v_mfma_f32_16x16x32_bf16 v[164:167], v[136:139], v[56:59], v[164:167]
    ds_read_b128 v[108:111], v6 offset:22528
    v_mfma_f32_16x16x32_bf16 v[192:195], v[136:139], v[60:63], v[192:195]
    buffer_load_dwordx4 v[40:43], v14, s[20:23], s48 offen offset:3072 sc1
    s_waitcnt lgkmcnt(6)
    v_mfma_f32_16x16x32_bf16 v[168:171], v[140:143], v[56:59], v[168:171]
    ds_read_b128 v[112:115], v6 offset:23552
    v_mfma_f32_16x16x32_bf16 v[196:199], v[140:143], v[60:63], v[196:199]
    s_waitcnt lgkmcnt(6)
    v_mfma_f32_16x16x32_bf16 v[172:175], v[144:147], v[56:59], v[172:175]
    ds_read_b128 v[116:119], v6 offset:24576
    v_mfma_f32_16x16x32_bf16 v[200:203], v[144:147], v[60:63], v[200:203]
    buffer_load_dwordx4 v[44:47], v14, s[20:23], s49 offen offset:3072 sc1
    s_waitcnt lgkmcnt(6)
    v_mfma_f32_16x16x32_bf16 v[176:179], v[148:151], v[56:59], v[176:179]
    ds_read_b128 v[120:123], v6 offset:25600
    v_mfma_f32_16x16x32_bf16 v[204:207], v[148:151], v[60:63], v[204:207]
    s_waitcnt lgkmcnt(6)
    v_mfma_f32_16x16x32_bf16 v[180:183], v[152:155], v[56:59], v[180:183]
    ds_read_b128 v[124:127], v6 offset:26624
    v_mfma_f32_16x16x32_bf16 v[208:211], v[152:155], v[60:63], v[208:211]
    s_waitcnt lgkmcnt(6)
    v_mfma_f32_16x16x32_bf16 v[184:187], v[156:159], v[56:59], v[184:187]
    ds_read_b128 v[128:131], v6 offset:27648
    v_mfma_f32_16x16x32_bf16 v[212:215], v[156:159], v[60:63], v[212:215]
    s_waitcnt vmcnt(7) lgkmcnt(6)
    v_mfma_f32_16x16x32_bf16 v[160:163], v[104:107], v[16:19], v[160:163]
    ds_read_b128 v[132:135], v6 offset:28672
    s_waitcnt vmcnt(6)
    v_mfma_f32_16x16x32_bf16 v[188:191], v[104:107], v[20:23], v[188:191]
    s_waitcnt lgkmcnt(6)
    v_mfma_f32_16x16x32_bf16 v[164:167], v[108:111], v[16:19], v[164:167]
    ds_read_b128 v[136:139], v6 offset:29696
    v_mfma_f32_16x16x32_bf16 v[192:195], v[108:111], v[20:23], v[192:195]
    s_waitcnt lgkmcnt(6)
    v_mfma_f32_16x16x32_bf16 v[168:171], v[112:115], v[16:19], v[168:171]
    ds_read_b128 v[140:143], v6 offset:30720
    v_mfma_f32_16x16x32_bf16 v[196:199], v[112:115], v[20:23], v[196:199]
    s_waitcnt lgkmcnt(6)
    v_mfma_f32_16x16x32_bf16 v[172:175], v[116:119], v[16:19], v[172:175]
    ds_read_b128 v[144:147], v6 offset:31744
    v_mfma_f32_16x16x32_bf16 v[200:203], v[116:119], v[20:23], v[200:203]
    s_waitcnt lgkmcnt(6)
    v_mfma_f32_16x16x32_bf16 v[176:179], v[120:123], v[16:19], v[176:179]
    ds_read_b128 v[148:151], v6 offset:32768
    v_mfma_f32_16x16x32_bf16 v[204:207], v[120:123], v[20:23], v[204:207]
    s_waitcnt lgkmcnt(6)
    v_mfma_f32_16x16x32_bf16 v[180:183], v[124:127], v[16:19], v[180:183]
    ds_read_b128 v[152:155], v6 offset:33792
    v_mfma_f32_16x16x32_bf16 v[208:211], v[124:127], v[20:23], v[208:211]
    s_waitcnt lgkmcnt(6)
    v_mfma_f32_16x16x32_bf16 v[184:187], v[128:131], v[16:19], v[184:187]
    ds_read_b128 v[156:159], v6 offset:34816
    v_mfma_f32_16x16x32_bf16 v[212:215], v[128:131], v[20:23], v[212:215]
    s_barrier
    s_waitcnt vmcnt(5) lgkmcnt(6)
    v_mfma_f32_16x16x32_bf16 v[160:163], v[132:135], v[24:27], v[160:163]
    ds_read_b128 v[64:67], v6 offset:35840
    s_waitcnt vmcnt(4)
    v_mfma_f32_16x16x32_bf16 v[188:191], v[132:135], v[28:31], v[188:191]
    ds_read_b128 v[68:71], v6 offset:36864
    s_waitcnt lgkmcnt(7)
    v_mfma_f32_16x16x32_bf16 v[164:167], v[136:139], v[24:27], v[164:167]
    ds_read_b128 v[72:75], v6 offset:43008
    v_mfma_f32_16x16x32_bf16 v[192:195], v[136:139], v[28:31], v[192:195]
    ds_read_b128 v[76:79], v6 offset:44032
    s_waitcnt lgkmcnt(8)
    v_mfma_f32_16x16x32_bf16 v[168:171], v[140:143], v[24:27], v[168:171]
    v_mfma_f32_16x16x32_bf16 v[196:199], v[140:143], v[28:31], v[196:199]
    s_waitcnt lgkmcnt(7)
    v_mfma_f32_16x16x32_bf16 v[172:175], v[144:147], v[24:27], v[172:175]
    v_mfma_f32_16x16x32_bf16 v[200:203], v[144:147], v[28:31], v[200:203]
    s_waitcnt lgkmcnt(6)
    v_mfma_f32_16x16x32_bf16 v[176:179], v[148:151], v[24:27], v[176:179]
    v_mfma_f32_16x16x32_bf16 v[204:207], v[148:151], v[28:31], v[204:207]
    s_waitcnt lgkmcnt(5)
    v_mfma_f32_16x16x32_bf16 v[180:183], v[152:155], v[24:27], v[180:183]
    v_mfma_f32_16x16x32_bf16 v[208:211], v[152:155], v[28:31], v[208:211]
    s_waitcnt lgkmcnt(4)
    v_mfma_f32_16x16x32_bf16 v[184:187], v[156:159], v[24:27], v[184:187]
    v_mfma_f32_16x16x32_bf16 v[212:215], v[156:159], v[28:31], v[212:215]
    s_waitcnt vmcnt(3) lgkmcnt(3)
    v_mfma_f32_16x16x32_bf16 v[160:163], v[64:67], v[32:35], v[160:163]
    ds_read_b128 v[104:107], v6 offset:37888
    s_waitcnt vmcnt(2)
    v_mfma_f32_16x16x32_bf16 v[188:191], v[64:67], v[36:39], v[188:191]
    ds_read_b128 v[108:111], v6 offset:38912
    s_waitcnt lgkmcnt(4)
    v_mfma_f32_16x16x32_bf16 v[164:167], v[68:71], v[32:35], v[164:167]
    ds_read_b128 v[112:115], v6 offset:45056
    v_mfma_f32_16x16x32_bf16 v[192:195], v[68:71], v[36:39], v[192:195]
    ds_read_b128 v[116:119], v6 offset:46080
    s_waitcnt vmcnt(1) lgkmcnt(5)
    v_mfma_f32_16x16x32_bf16 v[160:163], v[72:75], v[40:43], v[160:163]
    s_waitcnt vmcnt(0)
    v_mfma_f32_16x16x32_bf16 v[188:191], v[72:75], v[44:47], v[188:191]
    s_waitcnt lgkmcnt(4)
    v_mfma_f32_16x16x32_bf16 v[164:167], v[76:79], v[40:43], v[164:167]
    v_mfma_f32_16x16x32_bf16 v[192:195], v[76:79], v[44:47], v[192:195]
    s_waitcnt lgkmcnt(3)
    v_mfma_f32_16x16x32_bf16 v[168:171], v[104:107], v[32:35], v[168:171]
    ds_read_b128 v[64:67], v6 offset:39936
    v_mfma_f32_16x16x32_bf16 v[196:199], v[104:107], v[36:39], v[196:199]
    ds_read_b128 v[68:71], v6 offset:40960
    v_cvt_pk_bf16_f32 v216, v160, v161
    v_cvt_pk_bf16_f32 v220, v162, v163
    v_cvt_pk_bf16_f32 v224, v164, v165
    v_cvt_pk_bf16_f32 v228, v166, v167
    v_and_b32 v217, 0xffff0000, v216
    v_and_b32 v221, 0xffff0000, v220
    v_and_b32 v225, 0xffff0000, v224
    v_and_b32 v229, 0xffff0000, v228
    v_lshlrev_b32 v216, 16, v216
    v_lshlrev_b32 v220, 16, v220
    v_lshlrev_b32 v224, 16, v224
    v_lshlrev_b32 v228, 16, v228
    s_waitcnt lgkmcnt(4)
    v_mfma_f32_16x16x32_bf16 v[172:175], v[108:111], v[32:35], v[172:175]
    ds_read_b128 v[72:75], v6 offset:47104
    v_pk_mul_f32 v[218:219], v[216:217], s[56:57] op_sel_hi:[1,0]
    v_pk_mul_f32 v[222:223], v[220:221], s[56:57] op_sel_hi:[1,0]
    v_pk_mul_f32 v[226:227], v[224:225], s[56:57] op_sel_hi:[1,0]
    v_pk_mul_f32 v[230:231], v[228:229], s[56:57] op_sel_hi:[1,0]
    v_exp_f32 v218, v218
    v_exp_f32 v222, v222
    v_exp_f32 v226, v226
    v_exp_f32 v230, v230
    v_exp_f32 v219, v219
    v_exp_f32 v223, v223
    v_exp_f32 v227, v227
    v_exp_f32 v231, v231
    v_mfma_f32_16x16x32_bf16 v[200:203], v[108:111], v[36:39], v[200:203]
    ds_read_b128 v[76:79], v6 offset:48128
    v_pk_add_f32 v[218:219], v[218:219], 1.0 op_sel_hi:[1,0]
    v_pk_add_f32 v[222:223], v[222:223], 1.0 op_sel_hi:[1,0]
    v_pk_add_f32 v[226:227], v[226:227], 1.0 op_sel_hi:[1,0]
    v_pk_add_f32 v[230:231], v[230:231], 1.0 op_sel_hi:[1,0]
    v_rcp_f32 v218, v218
    v_rcp_f32 v222, v222
    v_rcp_f32 v226, v226
    v_rcp_f32 v230, v230
    v_rcp_f32 v219, v219
    v_rcp_f32 v223, v223
    v_rcp_f32 v227, v227
    v_rcp_f32 v231, v231
    s_waitcnt lgkmcnt(5)
    v_mfma_f32_16x16x32_bf16 v[168:171], v[112:115], v[40:43], v[168:171]
    v_pk_mul_f32 v[216:217], v[216:217], v[218:219]
    v_pk_mul_f32 v[220:221], v[220:221], v[222:223]
    v_pk_mul_f32 v[224:225], v[224:225], v[226:227]
    v_pk_mul_f32 v[228:229], v[228:229], v[230:231]
    v_cvt_pk_bf16_f32 v96, v216, v217
    v_cvt_pk_bf16_f32 v97, v220, v221
    v_cvt_pk_bf16_f32 v98, v224, v225
    v_cvt_pk_bf16_f32 v99, v228, v229
    buffer_store_dwordx4 v[96:99], v14, s[20:23], s52 offen offset:0 sc1
    v_cvt_pk_bf16_f32 v216, v188, v189
    v_cvt_pk_bf16_f32 v220, v190, v191
    v_cvt_pk_bf16_f32 v224, v192, v193
    v_mfma_f32_16x16x32_bf16 v[196:199], v[112:115], v[44:47], v[196:199]
    v_cvt_pk_bf16_f32 v228, v194, v195
    v_and_b32 v217, 0xffff0000, v216
    v_and_b32 v221, 0xffff0000, v220
    v_and_b32 v225, 0xffff0000, v224
    v_and_b32 v229, 0xffff0000, v228
    v_lshlrev_b32 v216, 16, v216
    v_lshlrev_b32 v220, 16, v220
    v_lshlrev_b32 v224, 16, v224
    v_lshlrev_b32 v228, 16, v228
    v_pk_mul_f32 v[218:219], v[216:217], s[56:57] op_sel_hi:[1,0]
    v_pk_mul_f32 v[222:223], v[220:221], s[56:57] op_sel_hi:[1,0]
    v_pk_mul_f32 v[226:227], v[224:225], s[56:57] op_sel_hi:[1,0]
    s_waitcnt lgkmcnt(4)
    v_mfma_f32_16x16x32_bf16 v[172:175], v[116:119], v[40:43], v[172:175]
    v_pk_mul_f32 v[230:231], v[228:229], s[56:57] op_sel_hi:[1,0]
    v_exp_f32 v218, v218
    v_exp_f32 v222, v222
    v_exp_f32 v226, v226
    v_exp_f32 v230, v230
    v_exp_f32 v219, v219
    v_exp_f32 v223, v223
    v_exp_f32 v227, v227
    v_exp_f32 v231, v231
    v_pk_add_f32 v[218:219], v[218:219], 1.0 op_sel_hi:[1,0]
    v_pk_add_f32 v[222:223], v[222:223], 1.0 op_sel_hi:[1,0]
    v_pk_add_f32 v[226:227], v[226:227], 1.0 op_sel_hi:[1,0]
    v_mfma_f32_16x16x32_bf16 v[200:203], v[116:119], v[44:47], v[200:203]
    v_pk_add_f32 v[230:231], v[230:231], 1.0 op_sel_hi:[1,0]
    v_rcp_f32 v218, v218
    v_rcp_f32 v222, v222
    v_rcp_f32 v226, v226
    v_rcp_f32 v230, v230
    v_rcp_f32 v219, v219
    v_rcp_f32 v223, v223
    v_rcp_f32 v227, v227
    v_rcp_f32 v231, v231
    v_pk_mul_f32 v[216:217], v[216:217], v[218:219]
    v_pk_mul_f32 v[220:221], v[220:221], v[222:223]
    v_pk_mul_f32 v[224:225], v[224:225], v[226:227]
    v_pk_mul_f32 v[228:229], v[228:229], v[230:231]
    v_cvt_pk_bf16_f32 v232, v216, v217
    v_cvt_pk_bf16_f32 v233, v220, v221
    v_cvt_pk_bf16_f32 v234, v224, v225
    v_cvt_pk_bf16_f32 v235, v228, v229
    buffer_store_dwordx4 v[232:235], v14, s[20:23], s53 offen offset:0 sc1
    s_waitcnt lgkmcnt(3)
    v_mfma_f32_16x16x32_bf16 v[176:179], v[64:67], v[32:35], v[176:179]
    ds_read_b128 v[104:107], v6 offset:41984
    v_mfma_f32_16x16x32_bf16 v[204:207], v[64:67], v[36:39], v[204:207]
    ds_read_b128 v[112:115], v6 offset:49152
    v_cvt_pk_bf16_f32 v216, v168, v169
    v_cvt_pk_bf16_f32 v220, v170, v171
    v_cvt_pk_bf16_f32 v224, v172, v173
    v_cvt_pk_bf16_f32 v228, v174, v175
    v_and_b32 v217, 0xffff0000, v216
    v_and_b32 v221, 0xffff0000, v220
    v_and_b32 v225, 0xffff0000, v224
    v_and_b32 v229, 0xffff0000, v228
    v_lshlrev_b32 v216, 16, v216
    v_lshlrev_b32 v220, 16, v220
    v_lshlrev_b32 v224, 16, v224
    v_lshlrev_b32 v228, 16, v228
    s_waitcnt lgkmcnt(4)
    v_mfma_f32_16x16x32_bf16 v[180:183], v[68:71], v[32:35], v[180:183]
    v_pk_mul_f32 v[218:219], v[216:217], s[56:57] op_sel_hi:[1,0]
    v_pk_mul_f32 v[222:223], v[220:221], s[56:57] op_sel_hi:[1,0]
    v_pk_mul_f32 v[226:227], v[224:225], s[56:57] op_sel_hi:[1,0]
    v_pk_mul_f32 v[230:231], v[228:229], s[56:57] op_sel_hi:[1,0]
    v_exp_f32 v218, v218
    v_exp_f32 v222, v222
    v_exp_f32 v226, v226
    v_exp_f32 v230, v230
    v_exp_f32 v219, v219
    v_exp_f32 v223, v223
    v_exp_f32 v227, v227
    v_exp_f32 v231, v231
    v_mfma_f32_16x16x32_bf16 v[208:211], v[68:71], v[36:39], v[208:211]
    v_pk_add_f32 v[218:219], v[218:219], 1.0 op_sel_hi:[1,0]
    v_pk_add_f32 v[222:223], v[222:223], 1.0 op_sel_hi:[1,0]
    v_pk_add_f32 v[226:227], v[226:227], 1.0 op_sel_hi:[1,0]
    v_pk_add_f32 v[230:231], v[230:231], 1.0 op_sel_hi:[1,0]
    v_rcp_f32 v218, v218
    v_rcp_f32 v222, v222
    v_rcp_f32 v226, v226
    v_rcp_f32 v230, v230
    v_rcp_f32 v219, v219
    v_rcp_f32 v223, v223
    v_rcp_f32 v227, v227
    v_rcp_f32 v231, v231
    s_waitcnt lgkmcnt(3)
    v_mfma_f32_16x16x32_bf16 v[176:179], v[72:75], v[40:43], v[176:179]
    v_pk_mul_f32 v[216:217], v[216:217], v[218:219]
    v_pk_mul_f32 v[220:221], v[220:221], v[222:223]
    v_pk_mul_f32 v[224:225], v[224:225], v[226:227]
    v_pk_mul_f32 v[228:229], v[228:229], v[230:231]
    v_cvt_pk_bf16_f32 v100, v216, v217
    v_cvt_pk_bf16_f32 v101, v220, v221
    v_cvt_pk_bf16_f32 v102, v224, v225
    v_cvt_pk_bf16_f32 v103, v228, v229
    buffer_store_dwordx4 v[100:103], v14, s[20:23], s52 offen offset:1024 sc1
    v_cvt_pk_bf16_f32 v216, v196, v197
    v_cvt_pk_bf16_f32 v220, v198, v199
    v_cvt_pk_bf16_f32 v224, v200, v201
    v_mfma_f32_16x16x32_bf16 v[204:207], v[72:75], v[44:47], v[204:207]
    v_cvt_pk_bf16_f32 v228, v202, v203
    v_and_b32 v217, 0xffff0000, v216
    v_and_b32 v221, 0xffff0000, v220
    v_and_b32 v225, 0xffff0000, v224
    v_and_b32 v229, 0xffff0000, v228
    v_lshlrev_b32 v216, 16, v216
    v_lshlrev_b32 v220, 16, v220
    v_lshlrev_b32 v224, 16, v224
    v_lshlrev_b32 v228, 16, v228
    v_pk_mul_f32 v[218:219], v[216:217], s[56:57] op_sel_hi:[1,0]
    v_pk_mul_f32 v[222:223], v[220:221], s[56:57] op_sel_hi:[1,0]
    v_pk_mul_f32 v[226:227], v[224:225], s[56:57] op_sel_hi:[1,0]
    s_waitcnt lgkmcnt(2)
    v_mfma_f32_16x16x32_bf16 v[180:183], v[76:79], v[40:43], v[180:183]
    v_pk_mul_f32 v[230:231], v[228:229], s[56:57] op_sel_hi:[1,0]
    v_exp_f32 v218, v218
    v_exp_f32 v222, v222
    v_exp_f32 v226, v226
    v_exp_f32 v230, v230
    v_exp_f32 v219, v219
    v_exp_f32 v223, v223
    v_exp_f32 v227, v227
    v_exp_f32 v231, v231
    v_pk_add_f32 v[218:219], v[218:219], 1.0 op_sel_hi:[1,0]
    v_pk_add_f32 v[222:223], v[222:223], 1.0 op_sel_hi:[1,0]
    v_pk_add_f32 v[226:227], v[226:227], 1.0 op_sel_hi:[1,0]
    v_mfma_f32_16x16x32_bf16 v[208:211], v[76:79], v[44:47], v[208:211]
    v_pk_add_f32 v[230:231], v[230:231], 1.0 op_sel_hi:[1,0]
    v_rcp_f32 v218, v218
    v_rcp_f32 v222, v222
    v_rcp_f32 v226, v226
    v_rcp_f32 v230, v230
    v_rcp_f32 v219, v219
    v_rcp_f32 v223, v223
    v_rcp_f32 v227, v227
    v_rcp_f32 v231, v231
    v_pk_mul_f32 v[216:217], v[216:217], v[218:219]
    v_pk_mul_f32 v[220:221], v[220:221], v[222:223]
    v_pk_mul_f32 v[224:225], v[224:225], v[226:227]
    v_pk_mul_f32 v[228:229], v[228:229], v[230:231]
    v_cvt_pk_bf16_f32 v236, v216, v217
    v_cvt_pk_bf16_f32 v237, v220, v221
    v_cvt_pk_bf16_f32 v238, v224, v225
    v_cvt_pk_bf16_f32 v239, v228, v229
    buffer_store_dwordx4 v[236:239], v14, s[20:23], s53 offen offset:1024 sc1
    s_waitcnt lgkmcnt(1)
    v_mfma_f32_16x16x32_bf16 v[184:187], v[104:107], v[32:35], v[184:187]
    v_mfma_f32_16x16x32_bf16 v[212:215], v[104:107], v[36:39], v[212:215]
    v_cvt_pk_bf16_f32 v216, v176, v177
    v_cvt_pk_bf16_f32 v220, v178, v179
    v_cvt_pk_bf16_f32 v224, v180, v181
    v_cvt_pk_bf16_f32 v228, v182, v183
    v_and_b32 v217, 0xffff0000, v216
    v_and_b32 v221, 0xffff0000, v220
    v_and_b32 v225, 0xffff0000, v224
    v_and_b32 v229, 0xffff0000, v228
    v_lshlrev_b32 v216, 16, v216
    v_lshlrev_b32 v220, 16, v220
    v_lshlrev_b32 v224, 16, v224
    v_lshlrev_b32 v228, 16, v228
    v_pk_mul_f32 v[218:219], v[216:217], s[56:57] op_sel_hi:[1,0]
    v_pk_mul_f32 v[222:223], v[220:221], s[56:57] op_sel_hi:[1,0]
    v_pk_mul_f32 v[226:227], v[224:225], s[56:57] op_sel_hi:[1,0]
    v_pk_mul_f32 v[230:231], v[228:229], s[56:57] op_sel_hi:[1,0]
    v_exp_f32 v218, v218
    v_exp_f32 v222, v222
    v_exp_f32 v226, v226
    v_exp_f32 v230, v230
    v_exp_f32 v219, v219
    v_exp_f32 v223, v223
    v_exp_f32 v227, v227
    s_waitcnt lgkmcnt(0)
    v_mfma_f32_16x16x32_bf16 v[184:187], v[112:115], v[40:43], v[184:187]
    v_exp_f32 v231, v231
    v_pk_add_f32 v[218:219], v[218:219], 1.0 op_sel_hi:[1,0]
    v_pk_add_f32 v[222:223], v[222:223], 1.0 op_sel_hi:[1,0]
    v_pk_add_f32 v[226:227], v[226:227], 1.0 op_sel_hi:[1,0]
    v_pk_add_f32 v[230:231], v[230:231], 1.0 op_sel_hi:[1,0]
    v_rcp_f32 v218, v218
    v_rcp_f32 v222, v222
    v_rcp_f32 v226, v226
    v_rcp_f32 v230, v230
    v_rcp_f32 v219, v219
    v_rcp_f32 v223, v223
    v_rcp_f32 v227, v227
    v_rcp_f32 v231, v231
    v_pk_mul_f32 v[216:217], v[216:217], v[218:219]
    v_pk_mul_f32 v[220:221], v[220:221], v[222:223]
    v_pk_mul_f32 v[224:225], v[224:225], v[226:227]
    v_pk_mul_f32 v[228:229], v[228:229], v[230:231]
    v_cvt_pk_bf16_f32 v96, v216, v217
    v_cvt_pk_bf16_f32 v97, v220, v221
    v_cvt_pk_bf16_f32 v98, v224, v225
    v_cvt_pk_bf16_f32 v99, v228, v229
    buffer_store_dwordx4 v[96:99], v14, s[20:23], s52 offen offset:2048 sc1
    v_cvt_pk_bf16_f32 v216, v204, v205
    v_mfma_f32_16x16x32_bf16 v[212:215], v[112:115], v[44:47], v[212:215]
    v_cvt_pk_bf16_f32 v220, v206, v207
    v_cvt_pk_bf16_f32 v224, v208, v209
    v_cvt_pk_bf16_f32 v228, v210, v211
    v_and_b32 v217, 0xffff0000, v216
    v_and_b32 v221, 0xffff0000, v220
    v_and_b32 v225, 0xffff0000, v224
    v_and_b32 v229, 0xffff0000, v228
    v_lshlrev_b32 v216, 16, v216
    v_lshlrev_b32 v220, 16, v220
    v_lshlrev_b32 v224, 16, v224
    v_lshlrev_b32 v228, 16, v228
    v_pk_mul_f32 v[218:219], v[216:217], s[56:57] op_sel_hi:[1,0]
    v_pk_mul_f32 v[222:223], v[220:221], s[56:57] op_sel_hi:[1,0]
    v_pk_mul_f32 v[226:227], v[224:225], s[56:57] op_sel_hi:[1,0]
    v_pk_mul_f32 v[230:231], v[228:229], s[56:57] op_sel_hi:[1,0]
    v_exp_f32 v218, v218
    v_exp_f32 v222, v222
    v_exp_f32 v226, v226
    v_exp_f32 v230, v230
    v_exp_f32 v219, v219
    v_exp_f32 v223, v223
    v_exp_f32 v227, v227
    v_exp_f32 v231, v231
    v_pk_add_f32 v[218:219], v[218:219], 1.0 op_sel_hi:[1,0]
    v_pk_add_f32 v[222:223], v[222:223], 1.0 op_sel_hi:[1,0]
    v_pk_add_f32 v[226:227], v[226:227], 1.0 op_sel_hi:[1,0]
    v_pk_add_f32 v[230:231], v[230:231], 1.0 op_sel_hi:[1,0]
    v_rcp_f32 v218, v218
    v_rcp_f32 v222, v222
    v_rcp_f32 v226, v226
    v_rcp_f32 v230, v230
    v_rcp_f32 v219, v219
    v_rcp_f32 v223, v223
    v_rcp_f32 v227, v227
    v_rcp_f32 v231, v231
    v_pk_mul_f32 v[216:217], v[216:217], v[218:219]
    v_pk_mul_f32 v[220:221], v[220:221], v[222:223]
    v_pk_mul_f32 v[224:225], v[224:225], v[226:227]
    v_pk_mul_f32 v[228:229], v[228:229], v[230:231]
    v_cvt_pk_bf16_f32 v232, v216, v217
    v_cvt_pk_bf16_f32 v233, v220, v221
    v_cvt_pk_bf16_f32 v234, v224, v225
    v_cvt_pk_bf16_f32 v235, v228, v229
    buffer_store_dwordx4 v[232:235], v14, s[20:23], s53 offen offset:2048 sc1
    v_cvt_pk_bf16_f32 v216, v184, v185
    v_cvt_pk_bf16_f32 v220, v186, v187
    v_and_b32 v217, 0xffff0000, v216
    v_and_b32 v221, 0xffff0000, v220
    v_lshlrev_b32 v216, 16, v216
    v_lshlrev_b32 v220, 16, v220
    v_pk_mul_f32 v[218:219], v[216:217], s[56:57] op_sel_hi:[1,0]
    v_pk_mul_f32 v[222:223], v[220:221], s[56:57] op_sel_hi:[1,0]
    v_exp_f32 v218, v218
    v_exp_f32 v222, v222
    v_exp_f32 v219, v219
    v_exp_f32 v223, v223
    v_pk_add_f32 v[218:219], v[218:219], 1.0 op_sel_hi:[1,0]
    v_pk_add_f32 v[222:223], v[222:223], 1.0 op_sel_hi:[1,0]
    v_rcp_f32 v218, v218
    v_rcp_f32 v222, v222
    v_rcp_f32 v219, v219
    v_rcp_f32 v223, v223
    v_pk_mul_f32 v[216:217], v[216:217], v[218:219]
    v_pk_mul_f32 v[220:221], v[220:221], v[222:223]
    v_cvt_pk_bf16_f32 v100, v216, v217
    v_cvt_pk_bf16_f32 v101, v220, v221
    buffer_store_dwordx2 v[100:101], v7, s[20:23], s51 offen sc1
    v_cvt_pk_bf16_f32 v216, v212, v213
    v_cvt_pk_bf16_f32 v220, v214, v215
    v_and_b32 v217, 0xffff0000, v216
    v_and_b32 v221, 0xffff0000, v220
    v_lshlrev_b32 v216, 16, v216
    v_lshlrev_b32 v220, 16, v220
    v_pk_mul_f32 v[218:219], v[216:217], s[56:57] op_sel_hi:[1,0]
    v_pk_mul_f32 v[222:223], v[220:221], s[56:57] op_sel_hi:[1,0]
    v_exp_f32 v218, v218
    v_exp_f32 v222, v222
    v_exp_f32 v219, v219
    v_exp_f32 v223, v223
    v_pk_add_f32 v[218:219], v[218:219], 1.0 op_sel_hi:[1,0]
    v_pk_add_f32 v[222:223], v[222:223], 1.0 op_sel_hi:[1,0]
    v_rcp_f32 v218, v218
    v_rcp_f32 v222, v222
    v_rcp_f32 v219, v219
    v_rcp_f32 v223, v223
    v_pk_mul_f32 v[216:217], v[216:217], v[218:219]
    v_pk_mul_f32 v[220:221], v[220:221], v[222:223]
    v_cvt_pk_bf16_f32 v236, v216, v217
    v_cvt_pk_bf16_f32 v237, v220, v221
    buffer_store_dwordx2 v[236:237], v7, s[20:23], s54 offen sc1
    s_lshl_b32 s49, s41, 1
    s_add_u32 s48, s63, s49
    v_add_u32 v8, 57344, v14
    v_add_u32 v9, 114688, v14
    v_add_u32 v10, 172032, v14
    v_and_b32 v4, 3, v1
    v_lshlrev_b32 v4, 5, v4
    v_and_b32 v5, 4, v1
    v_lshl_add_u32 v4, v5, 2, v4
    v_bfe_u32 v5, v1, 3, 1
    v_lshl_add_u32 v6, v3, 2, v5
    v_lshl_add_u32 v6, v6, 10, v4
    s_lshl_b32 s50, s48, 16
    s_lshr_b32 s51, s40, 1
    s_lshl_b32 s52, s51, 14
    s_add_u32 s50, s50, s52
    s_and_b32 s52, s40, 1
    s_lshl_b32 s53, s52, 11
    s_add_u32 s50, s50, s53
    s_lshl_b32 s53, s62, 7
    s_add_u32 s50, s50, s53
    s_add_u32 s50, s50, 6406144
    v_lshrrev_b32 v15, 1, v3
    v_lshlrev_b32 v15, 18, v15
    v_and_b32 v240, 1, v3
    v_lshl_add_u32 v15, v240, 17, v15
    v_lshl_add_u32 v15, v5, 15, v15
    v_add_u32 v15, v15, v4
    s_lshr_b32 s54, s41, 3
    s_lshl_b32 s54, s54, 20
    s_and_b32 s55, s51, 1
    s_lshl_b32 s55, s55, 19
    s_add_u32 s54, s54, s55
    s_lshl_b32 s55, s52, 16
    s_add_u32 s54, s54, s55
    s_and_b32 s55, s41, 7
    s_lshl_b32 s55, s55, 12
    s_add_u32 s54, s54, s55
    s_lshl_b32 s55, s63, 11
    s_add_u32 s54, s54, s55
    s_lshr_b32 s55, s51, 1
    s_lshl_b32 s55, s55, 10
    s_add_u32 s54, s54, s55
    s_add_u32 s54, s54, s53
    v_and_b32 v4, 3, v1
    v_lshl_add_u32 v4, v4, 2, v5
    v_mul_u32_u24 v4, 272, v4
    v_lshl_add_u32 v4, v3, 6, v4
    v_and_b32 v5, 4, v1
    v_lshl_add_u32 v4, v5, 3, v4
    s_mul_i32 s55, s51, 4352
    s_mul_i32 s53, s52, 544
    s_add_u32 s55, s55, s53
    v_add_u32 v4, s55, v4
    v_add_u32 v5, 69632, v4
    s_mul_i32 s55, s40, 17408
    s_mul_i32 s49, s48, 224
    s_mul_i32 s53, s40, 7
    s_add_u32 s49, s49, s53
    s_add_u32 s49, s49, 28
    s_lshl_b32 s49, s49, 10
    s_add_u32 s49, s49, 12435456
    s_mul_i32 s53, s40, 17408
    v_add_u32 v12, s53, v14
    s_mul_i32 s53, s40, 12288
    s_add_u32 s53, s53, 114688
    v_add_u32 v11, s53, v14
    s_waitcnt vmcnt(0)
    s_barrier
    s_cmp_lg_u32 s40, 0
    s_cbranch_scc1 LF2_nopub
    v_mov_b32 v240, 1
    v_mov_b32 v241, 0
    s_mov_b64 exec, 1
    buffer_store_dword v240, v241, s[20:23], s47 offen sc1
    s_mov_b64 exec, -1
LF2_nopub:
    s_setprio 0
    ds_read_b128 v[80:83], v11 offset:0
    ds_read_b128 v[84:87], v11 offset:1024
    ds_read_b128 v[88:91], v11 offset:2048
    ds_read_b128 v[92:95], v11 offset:3072
    v_and_b32 v242, 1, v1
    v_lshlrev_b32 v242, 2, v242
    s_mov_b32 s58, 200000
    buffer_load_dword v243, v242, s[20:23], s46 offen sc1
    buffer_load_dword v244, v242, s[20:23], s46 offen sc1
LF2_poll:
    s_waitcnt vmcnt(1)
    v_cmp_eq_u32 vcc, 1, v243
    buffer_load_dword v243, v242, s[20:23], s46 offen sc1
    s_nop 2
    s_cmp_eq_u64 vcc, exec
    s_cbranch_scc1 LF2_join
    s_waitcnt vmcnt(1)
    v_cmp_eq_u32 vcc, 1, v244
    buffer_load_dword v244, v242, s[20:23], s46 offen sc1
    s_nop 2
    s_cmp_eq_u64 vcc, exec
    s_cbranch_scc1 LF2_join
    s_sub_u32 s58, s58, 1
    s_cmp_lg_u32 s58, 0
    s_cbranch_scc1 LF2_poll
LF2_join:
    s_nop 1
    buffer_load_dwordx4 v[16:19], v14, s[20:23], s49 offen sc1
    buffer_load_dwordx4 v[20:23], v8, s[20:23], s49 offen sc1
    buffer_load_dwordx4 v[24:27], v9, s[20:23], s49 offen sc1
    buffer_load_dwordx4 v[28:31], v10, s[20:23], s49 offen sc1
    s_add_u32 s49, s49, 1024
    buffer_load_dwordx4 v[32:35], v14, s[20:23], s49 offen sc1
    buffer_load_dwordx4 v[36:39], v8, s[20:23], s49 offen sc1
    buffer_load_dwordx4 v[40:43], v9, s[20:23], s49 offen sc1
    buffer_load_dwordx4 v[44:47], v10, s[20:23], s49 offen sc1
    s_add_u32 s49, s49, 1024
    buffer_load_dwordx4 v[48:51], v14, s[20:23], s49 offen sc1
    buffer_load_dwordx4 v[52:55], v8, s[20:23], s49 offen sc1
    buffer_load_dwordx4 v[56:59], v9, s[20:23], s49 offen sc1
    buffer_load_dwordx4 v[60:63], v10, s[20:23], s49 offen sc1
    s_add_u32 s49, s49, 1024
    s_mov_b32 m0, s55
    s_waitcnt vmcnt(11) lgkmcnt(3)
    v_mfma_f32_16x16x32_bf16 v[192:195], v[16:19], v[80:83], 0
    s_waitcnt lgkmcnt(2)
    v_mfma_f32_16x16x32_bf16 v[196:199], v[16:19], v[84:87], 0
    s_waitcnt lgkmcnt(1)
    v_mfma_f32_16x16x32_bf16 v[200:203], v[16:19], v[88:91], 0
    s_waitcnt lgkmcnt(0)
    v_mfma_f32_16x16x32_bf16 v[204:207], v[16:19], v[92:95], 0
    buffer_load_dwordx4 v[64:67], v14, s[20:23], s49 offen sc1
    ds_read_b128 v[96:99], v11 offset:4096
    s_waitcnt vmcnt(11)
    v_mfma_f32_16x16x32_bf16 v[208:211], v[20:23], v[80:83], 0
    v_mfma_f32_16x16x32_bf16 v[212:215], v[20:23], v[84:87], 0
    v_mfma_f32_16x16x32_bf16 v[216:219], v[20:23], v[88:91], 0
    v_mfma_f32_16x16x32_bf16 v[220:223], v[20:23], v[92:95], 0
    buffer_load_dwordx4 v[68:71], v8, s[20:23], s49 offen sc1
    ds_read_b128 v[100:103], v11 offset:5120
    s_waitcnt vmcnt(11)
    v_mfma_f32_16x16x32_bf16 v[224:227], v[24:27], v[80:83], 0
    v_mfma_f32_16x16x32_bf16 v[228:231], v[24:27], v[84:87], 0
    v_mfma_f32_16x16x32_bf16 v[232:235], v[24:27], v[88:91], 0
    v_mfma_f32_16x16x32_bf16 v[236:239], v[24:27], v[92:95], 0
    buffer_load_dwordx4 v[72:75], v9, s[20:23], s49 offen sc1
    ds_read_b128 v[104:107], v11 offset:6144
    s_waitcnt vmcnt(11)
    v_mfma_f32_16x16x32_bf16 v[240:243], v[28:31], v[80:83], 0
    v_mfma_f32_16x16x32_bf16 v[244:247], v[28:31], v[84:87], 0
    v_mfma_f32_16x16x32_bf16 v[248:251], v[28:31], v[88:91], 0
    v_mfma_f32_16x16x32_bf16 v[252:255], v[28:31], v[92:95], 0
    buffer_load_dwordx4 v[76:79], v10, s[20:23], s49 offen sc1
    s_add_u32 s49, s49, 1024
    ds_read_b128 v[108:111], v11 offset:7168
    s_waitcnt vmcnt(11) lgkmcnt(3)
    v_mfma_f32_16x16x32_bf16 v[192:195], v[32:35], v[96:99], v[192:195]
    s_waitcnt lgkmcnt(2)
    v_mfma_f32_16x16x32_bf16 v[196:199], v[32:35], v[100:103], v[196:199]
    s_waitcnt lgkmcnt(1)
    v_mfma_f32_16x16x32_bf16 v[200:203], v[32:35], v[104:107], v[200:203]
    s_waitcnt lgkmcnt(0)
    v_mfma_f32_16x16x32_bf16 v[204:207], v[32:35], v[108:111], v[204:207]
    buffer_load_dwordx4 v[16:19], v14, s[20:23], s49 offen sc1
    ds_read_b128 v[80:83], v11 offset:8192
    s_waitcnt vmcnt(11)
    v_mfma_f32_16x16x32_bf16 v[208:211], v[36:39], v[96:99], v[208:211]
    v_mfma_f32_16x16x32_bf16 v[212:215], v[36:39], v[100:103], v[212:215]
    v_mfma_f32_16x16x32_bf16 v[216:219], v[36:39], v[104:107], v[216:219]
    v_mfma_f32_16x16x32_bf16 v[220:223], v[36:39], v[108:111], v[220:223]
    buffer_load_dwordx4 v[20:23], v8, s[20:23], s49 offen sc1
    ds_read_b128 v[84:87], v11 offset:9216
    s_waitcnt vmcnt(11)
    v_mfma_f32_16x16x32_bf16 v[224:227], v[40:43], v[96:99], v[224:227]
    v_mfma_f32_16x16x32_bf16 v[228:231], v[40:43], v[100:103], v[228:231]
    v_mfma_f32_16x16x32_bf16 v[232:235], v[40:43], v[104:107], v[232:235]
    v_mfma_f32_16x16x32_bf16 v[236:239], v[40:43], v[108:111], v[236:239]
    buffer_load_dwordx4 v[24:27], v9, s[20:23], s49 offen sc1
    ds_read_b128 v[88:91], v11 offset:10240
    s_waitcnt vmcnt(11)
    v_mfma_f32_16x16x32_bf16 v[240:243], v[44:47], v[96:99], v[240:243]
    v_mfma_f32_16x16x32_bf16 v[244:247], v[44:47], v[100:103], v[244:247]
    v_mfma_f32_16x16x32_bf16 v[248:251], v[44:47], v[104:107], v[248:251]
    v_mfma_f32_16x16x32_bf16 v[252:255], v[44:47], v[108:111], v[252:255]
    buffer_load_dwordx4 v[28:31], v10, s[20:23], s49 offen sc1
    s_add_u32 s49, s49, 1024
    ds_read_b128 v[92:95], v11 offset:11264
    s_waitcnt vmcnt(11) lgkmcnt(3)
    v_mfma_f32_16x16x32_bf16 v[192:195], v[48:51], v[80:83], v[192:195]
    s_waitcnt lgkmcnt(2)
    v_mfma_f32_16x16x32_bf16 v[196:199], v[48:51], v[84:87], v[196:199]
    s_waitcnt lgkmcnt(1)
    v_mfma_f32_16x16x32_bf16 v[200:203], v[48:51], v[88:91], v[200:203]
    s_waitcnt lgkmcnt(0)
    v_mfma_f32_16x16x32_bf16 v[204:207], v[48:51], v[92:95], v[204:207]
    buffer_load_dwordx4 v[32:35], v14, s[20:23], s49 offen sc1
    ds_read_b128 v[96:99], v12 offset:0
    s_waitcnt vmcnt(11)
    v_mfma_f32_16x16x32_bf16 v[208:211], v[52:55], v[80:83], v[208:211]
    v_mfma_f32_16x16x32_bf16 v[212:215], v[52:55], v[84:87], v[212:215]
    v_mfma_f32_16x16x32_bf16 v[216:219], v[52:55], v[88:91], v[216:219]
    v_mfma_f32_16x16x32_bf16 v[220:223], v[52:55], v[92:95], v[220:223]
    buffer_load_dwordx4 v[36:39], v8, s[20:23], s49 offen sc1
    ds_read_b128 v[100:103], v12 offset:1024
    s_waitcnt vmcnt(11)
    v_mfma_f32_16x16x32_bf16 v[224:227], v[56:59], v[80:83], v[224:227]
    v_mfma_f32_16x16x32_bf16 v[228:231], v[56:59], v[84:87], v[228:231]
    v_mfma_f32_16x16x32_bf16 v[232:235], v[56:59], v[88:91], v[232:235]
    v_mfma_f32_16x16x32_bf16 v[236:239], v[56:59], v[92:95], v[236:239]
    buffer_load_dwordx4 v[40:43], v9, s[20:23], s49 offen sc1
    ds_read_b128 v[104:107], v12 offset:2048
    s_waitcnt vmcnt(11)
    v_mfma_f32_16x16x32_bf16 v[240:243], v[60:63], v[80:83], v[240:243]
    v_mfma_f32_16x16x32_bf16 v[244:247], v[60:63], v[84:87], v[244:247]
    v_mfma_f32_16x16x32_bf16 v[248:251], v[60:63], v[88:91], v[248:251]
    v_mfma_f32_16x16x32_bf16 v[252:255], v[60:63], v[92:95], v[252:255]
    buffer_load_dwordx4 v[44:47], v10, s[20:23], s49 offen sc1
    s_add_u32 s49, s49, 1024
    ds_read_b128 v[108:111], v12 offset:3072
    s_barrier
    s_waitcnt vmcnt(11) lgkmcnt(3)
    v_mfma_f32_16x16x32_bf16 v[192:195], v[64:67], v[96:99], v[192:195]
    s_waitcnt lgkmcnt(2)
    v_mfma_f32_16x16x32_bf16 v[196:199], v[64:67], v[100:103], v[196:199]
    s_waitcnt lgkmcnt(1)
    v_mfma_f32_16x16x32_bf16 v[200:203], v[64:67], v[104:107], v[200:203]
    s_waitcnt lgkmcnt(0)
    v_mfma_f32_16x16x32_bf16 v[204:207], v[64:67], v[108:111], v[204:207]
    v_lshrrev_b32 v13, 1, v14
    buffer_load_dwordx2 v[48:49], v13, s[20:23], s49 offen sc1
    buffer_load_dwordx2 v[50:51], v13, s[20:23], s49 offen offset:512 sc1
    ds_read_b128 v[80:83], v12 offset:4096
    s_waitcnt vmcnt(12)
    v_mfma_f32_16x16x32_bf16 v[208:211], v[68:71], v[96:99], v[208:211]
    v_mfma_f32_16x16x32_bf16 v[212:215], v[68:71], v[100:103], v[212:215]
    v_mfma_f32_16x16x32_bf16 v[216:219], v[68:71], v[104:107], v[216:219]
    v_mfma_f32_16x16x32_bf16 v[220:223], v[68:71], v[108:111], v[220:223]
    v_add_u32 v13, 57344, v13
    buffer_load_dwordx2 v[52:53], v13, s[20:23], s49 offen sc1
    buffer_load_dwordx2 v[54:55], v13, s[20:23], s49 offen offset:512 sc1
    ds_read_b128 v[84:87], v12 offset:5120
    s_waitcnt vmcnt(13)
    v_mfma_f32_16x16x32_bf16 v[224:227], v[72:75], v[96:99], v[224:227]
    v_mfma_f32_16x16x32_bf16 v[228:231], v[72:75], v[100:103], v[228:231]
    v_mfma_f32_16x16x32_bf16 v[232:235], v[72:75], v[104:107], v[232:235]
    v_mfma_f32_16x16x32_bf16 v[236:239], v[72:75], v[108:111], v[236:239]
    v_add_u32 v13, 57344, v13
    buffer_load_dwordx2 v[56:57], v13, s[20:23], s49 offen sc1
    buffer_load_dwordx2 v[58:59], v13, s[20:23], s49 offen offset:512 sc1
    ds_read_b128 v[88:91], v12 offset:6144
    s_waitcnt vmcnt(14)
    v_mfma_f32_16x16x32_bf16 v[240:243], v[76:79], v[96:99], v[240:243]
    v_mfma_f32_16x16x32_bf16 v[244:247], v[76:79], v[100:103], v[244:247]
    v_mfma_f32_16x16x32_bf16 v[248:251], v[76:79], v[104:107], v[248:251]
    v_mfma_f32_16x16x32_bf16 v[252:255], v[76:79], v[108:111], v[252:255]
    v_add_u32 v13, 57344, v13
    buffer_load_dwordx2 v[60:61], v13, s[20:23], s49 offen sc1
    buffer_load_dwordx2 v[62:63], v13, s[20:23], s49 offen offset:512 sc1
    ds_read_b128 v[92:95], v12 offset:7168
    buffer_load_dwordx4 v[64:67], v6, s[20:23], s50 offen sc1
    s_waitcnt vmcnt(16) lgkmcnt(3)
    v_mfma_f32_16x16x32_bf16 v[192:195], v[16:19], v[80:83], v[192:195]
    s_waitcnt lgkmcnt(2)
    v_mfma_f32_16x16x32_bf16 v[196:199], v[16:19], v[84:87], v[196:199]
    s_waitcnt lgkmcnt(1)
    v_mfma_f32_16x16x32_bf16 v[200:203], v[16:19], v[88:91], v[200:203]
    s_waitcnt lgkmcnt(0)
    v_mfma_f32_16x16x32_bf16 v[204:207], v[16:19], v[92:95], v[204:207]
    ds_read_b128 v[96:99], v12 offset:8192
    s_waitcnt vmcnt(15)
    v_mfma_f32_16x16x32_bf16 v[208:211], v[20:23], v[80:83], v[208:211]
    v_mfma_f32_16x16x32_bf16 v[212:215], v[20:23], v[84:87], v[212:215]
    v_mfma_f32_16x16x32_bf16 v[216:219], v[20:23], v[88:91], v[216:219]
    v_mfma_f32_16x16x32_bf16 v[220:223], v[20:23], v[92:95], v[220:223]
    ds_read_b128 v[100:103], v12 offset:9216
    s_waitcnt vmcnt(14)
    v_mfma_f32_16x16x32_bf16 v[224:227], v[24:27], v[80:83], v[224:227]
    v_mfma_f32_16x16x32_bf16 v[228:231], v[24:27], v[84:87], v[228:231]
    v_mfma_f32_16x16x32_bf16 v[232:235], v[24:27], v[88:91], v[232:235]
    v_mfma_f32_16x16x32_bf16 v[236:239], v[24:27], v[92:95], v[236:239]
    ds_read_b128 v[104:107], v12 offset:10240
    s_waitcnt vmcnt(13)
    v_mfma_f32_16x16x32_bf16 v[240:243], v[28:31], v[80:83], v[240:243]
    v_mfma_f32_16x16x32_bf16 v[244:247], v[28:31], v[84:87], v[244:247]
    v_mfma_f32_16x16x32_bf16 v[248:251], v[28:31], v[88:91], v[248:251]
    v_mfma_f32_16x16x32_bf16 v[252:255], v[28:31], v[92:95], v[252:255]
    ds_read_b128 v[108:111], v12 offset:11264
    s_waitcnt vmcnt(12) lgkmcnt(3)
    v_mfma_f32_16x16x32_bf16 v[192:195], v[32:35], v[96:99], v[192:195]
    s_waitcnt lgkmcnt(2)
    v_mfma_f32_16x16x32_bf16 v[196:199], v[32:35], v[100:103], v[196:199]
    s_waitcnt lgkmcnt(1)
    v_mfma_f32_16x16x32_bf16 v[200:203], v[32:35], v[104:107], v[200:203]
    s_waitcnt lgkmcnt(0)
    v_mfma_f32_16x16x32_bf16 v[204:207], v[32:35], v[108:111], v[204:207]
    ds_read_b128 v[80:83], v12 offset:12288
    s_waitcnt vmcnt(11)
    v_mfma_f32_16x16x32_bf16 v[208:211], v[36:39], v[96:99], v[208:211]
    v_mfma_f32_16x16x32_bf16 v[212:215], v[36:39], v[100:103], v[212:215]
    v_mfma_f32_16x16x32_bf16 v[216:219], v[36:39], v[104:107], v[216:219]
    v_mfma_f32_16x16x32_bf16 v[220:223], v[36:39], v[108:111], v[220:223]
    ds_read_b128 v[84:87], v12 offset:13312
    s_waitcnt vmcnt(10)
    v_mfma_f32_16x16x32_bf16 v[224:227], v[40:43], v[96:99], v[224:227]
    v_mfma_f32_16x16x32_bf16 v[228:231], v[40:43], v[100:103], v[228:231]
    v_mfma_f32_16x16x32_bf16 v[232:235], v[40:43], v[104:107], v[232:235]
    v_mfma_f32_16x16x32_bf16 v[236:239], v[40:43], v[108:111], v[236:239]
    ds_read_b128 v[88:91], v12 offset:14336
    s_waitcnt vmcnt(9)
    v_mfma_f32_16x16x32_bf16 v[240:243], v[44:47], v[96:99], v[240:243]
    v_mfma_f32_16x16x32_bf16 v[244:247], v[44:47], v[100:103], v[244:247]
    v_mfma_f32_16x16x32_bf16 v[248:251], v[44:47], v[104:107], v[248:251]
    v_mfma_f32_16x16x32_bf16 v[252:255], v[44:47], v[108:111], v[252:255]
    ds_read_b128 v[92:95], v12 offset:15360
    s_waitcnt vmcnt(7) lgkmcnt(3)
    v_mfma_f32_16x16x32_bf16 v[192:195], v[48:51], v[80:83], v[192:195]
    s_waitcnt lgkmcnt(2)
    v_mfma_f32_16x16x32_bf16 v[196:199], v[48:51], v[84:87], v[196:199]
    s_waitcnt lgkmcnt(1)
    v_mfma_f32_16x16x32_bf16 v[200:203], v[48:51], v[88:91], v[200:203]
    s_waitcnt lgkmcnt(0)
    v_mfma_f32_16x16x32_bf16 v[204:207], v[48:51], v[92:95], v[204:207]
    s_waitcnt vmcnt(5)
    v_mfma_f32_16x16x32_bf16 v[208:211], v[52:55], v[80:83], v[208:211]
    v_mfma_f32_16x16x32_bf16 v[212:215], v[52:55], v[84:87], v[212:215]
    v_mfma_f32_16x16x32_bf16 v[216:219], v[52:55], v[88:91], v[216:219]
    v_mfma_f32_16x16x32_bf16 v[220:223], v[52:55], v[92:95], v[220:223]
    s_waitcnt vmcnt(3)
    v_mfma_f32_16x16x32_bf16 v[224:227], v[56:59], v[80:83], v[224:227]
    v_mfma_f32_16x16x32_bf16 v[228:231], v[56:59], v[84:87], v[228:231]
    v_mfma_f32_16x16x32_bf16 v[232:235], v[56:59], v[88:91], v[232:235]
    v_mfma_f32_16x16x32_bf16 v[236:239], v[56:59], v[92:95], v[236:239]
    s_waitcnt vmcnt(1)
    v_mfma_f32_16x16x32_bf16 v[240:243], v[60:63], v[80:83], v[240:243]
    v_mfma_f32_16x16x32_bf16 v[244:247], v[60:63], v[84:87], v[244:247]
    v_mfma_f32_16x16x32_bf16 v[248:251], v[60:63], v[88:91], v[248:251]
    v_mfma_f32_16x16x32_bf16 v[252:255], v[60:63], v[92:95], v[252:255]
    s_branch LF_red
LF_L:
    s_sub_u32 s42, s40, 4
    s_mul_i32 s52, s42, 28672
    s_mul_i32 s51, s43, 114688
    s_add_u32 s51, s51, s52
    s_add_u32 s51, s51, 19775488
    s_mul_i32 s59, s62, 56
    s_mul_i32 s53, s42, 7
    s_add_u32 s53, s53, s59
    s_add_u32 s59, s53, 28
    s_lshl_b32 s53, s53, 12
    s_add_u32 s53, s53, 10600448
    s_lshl_b32 s59, s59, 12
    s_add_u32 s59, s59, 10600448
    s_mul_i32 s56, s42, 12288
    s_mul_i32 s57, s42, 17408
    s_waitcnt lgkmcnt(0)
    s_mov_b32 s20, s10
    s_and_b32 s21, s11, 0xffff
    s_mov_b32 s22, 25165824
    s_mov_b32 s23, 0x20000
    s_mov_b32 s28, s8
    s_and_b32 s29, s9, 0xffff
    s_mov_b32 s30, 2097152
    s_mov_b32 s31, 0x20000
    s_add_u32 m0, s52, 0
    s_nop 0
    buffer_load_dwordx4 v14, s[20:23], s51 offen offset:0 lds
    buffer_load_dwordx4 v14, s[20:23], s51 offen offset:1024 lds
    buffer_load_dwordx4 v14, s[20:23], s51 offen offset:2048 lds
    buffer_load_dwordx4 v14, s[20:23], s51 offen offset:3072 lds
    s_add_u32 s51, s51, 4096
    s_add_u32 m0, s52, 4096
    s_nop 0
    buffer_load_dwordx4 v14, s[20:23], s51 offen offset:0 lds
    buffer_load_dwordx4 v14, s[20:23], s51 offen offset:1024 lds
    buffer_load_dwordx4 v14, s[20:23], s51 offen offset:2048 lds
    buffer_load_dwordx4 v14, s[20:23], s51 offen offset:3072 lds
    s_add_u32 s51, s51, 4096
    s_add_u32 m0, s52, 8192
    s_nop 0
    buffer_load_dwordx4 v14, s[20:23], s51 offen offset:0 lds
    buffer_load_dwordx4 v14, s[20:23], s51 offen offset:1024 lds
    buffer_load_dwordx4 v14, s[20:23], s51 offen offset:2048 lds
    buffer_load_dwordx4 v14, s[20:23], s51 offen offset:3072 lds
    s_add_u32 s51, s51, 4096
    s_add_u32 m0, s52, 12288
    s_nop 0
    buffer_load_dwordx4 v14, s[20:23], s51 offen offset:0 lds
    buffer_load_dwordx4 v14, s[20:23], s51 offen offset:1024 lds
    buffer_load_dwordx4 v14, s[20:23], s51 offen offset:2048 lds
    buffer_load_dwordx4 v14, s[20:23], s51 offen offset:3072 lds
    s_add_u32 s51, s51, 4096
    s_barrier
    s_add_u32 m0, s52, 16384
    s_nop 0
    buffer_load_dwordx4 v14, s[20:23], s51 offen offset:0 lds
    buffer_load_dwordx4 v14, s[20:23], s51 offen offset:1024 lds
    buffer_load_dwordx4 v14, s[20:23], s51 offen offset:2048 lds
    buffer_load_dwordx4 v14, s[20:23], s51 offen offset:3072 lds
    s_add_u32 s51, s51, 4096
    s_add_u32 m0, s52, 20480
    s_nop 0
    buffer_load_dwordx4 v14, s[20:23], s51 offen offset:0 lds
    buffer_load_dwordx4 v14, s[20:23], s51 offen offset:1024 lds
    buffer_load_dwordx4 v14, s[20:23], s51 offen offset:2048 lds
    buffer_load_dwordx4 v14, s[20:23], s51 offen offset:3072 lds
    s_add_u32 s51, s51, 4096
    s_add_u32 m0, s52, 24576
    s_nop 0
    buffer_load_dwordx4 v14, s[20:23], s51 offen offset:0 lds
    buffer_load_dwordx4 v14, s[20:23], s51 offen offset:1024 lds
    buffer_load_dwordx4 v14, s[20:23], s51 offen offset:2048 lds
    buffer_load_dwordx4 v14, s[20:23], s51 offen offset:3072 lds
    s_add_u32 s51, s51, 4096
    buffer_load_dwordx4 v[80:83], v14, s[20:23], s53 offen offset:0
    buffer_load_dwordx4 v[84:87], v14, s[20:23], s53 offen offset:1024
    buffer_load_dwordx4 v[88:91], v14, s[20:23], s53 offen offset:2048
    buffer_load_dwordx4 v[92:95], v14, s[20:23], s53 offen offset:3072
    s_add_u32 s53, s53, 4096
    s_barrier
    buffer_load_dwordx4 v[96:99], v14, s[20:23], s53 offen offset:0
    buffer_load_dwordx4 v[100:103], v14, s[20:23], s53 offen offset:1024
    buffer_load_dwordx4 v[104:107], v14, s[20:23], s53 offen offset:2048
    buffer_load_dwordx4 v[108:111], v14, s[20:23], s53 offen offset:3072
    s_add_u32 s53, s53, 4096
    buffer_load_dwordx4 v[112:115], v14, s[20:23], s53 offen offset:0
    buffer_load_dwordx4 v[116:119], v14, s[20:23], s53 offen offset:1024
    buffer_load_dwordx4 v[120:123], v14, s[20:23], s53 offen offset:2048
    buffer_load_dwordx4 v[124:127], v14, s[20:23], s53 offen offset:3072
    s_add_u32 s53, s53, 4096
    s_barrier
    buffer_load_dwordx4 v[128:131], v14, s[20:23], s53 offen offset:0
    buffer_load_dwordx4 v[132:135], v14, s[20:23], s53 offen offset:1024
    buffer_load_dwordx4 v[136:139], v14, s[20:23], s53 offen offset:2048
    buffer_load_dwordx4 v[140:143], v14, s[20:23], s53 offen offset:3072
    s_add_u32 s53, s53, 4096
    buffer_load_dwordx4 v[144:147], v14, s[20:23], s53 offen offset:0
    buffer_load_dwordx4 v[148:151], v14, s[20:23], s53 offen offset:1024
    buffer_load_dwordx4 v[152:155], v14, s[20:23], s53 offen offset:2048
    buffer_load_dwordx4 v[156:159], v14, s[20:23], s53 offen offset:3072
    s_add_u32 s53, s53, 4096
    buffer_load_dwordx4 v[160:163], v14, s[20:23], s53 offen offset:0
    buffer_load_dwordx4 v[164:167], v14, s[20:23], s53 offen offset:1024
    buffer_load_dwordx4 v[168:171], v14, s[20:23], s53 offen offset:2048
    buffer_load_dwordx4 v[172:175], v14, s[20:23], s53 offen offset:3072
    s_add_u32 s53, s53, 4096
    buffer_load_dwordx4 v[176:179], v14, s[20:23], s53 offen offset:0
    buffer_load_dwordx4 v[180:183], v14, s[20:23], s53 offen offset:1024
    buffer_load_dwordx4 v[184:187], v14, s[20:23], s53 offen offset:2048
    buffer_load_dwordx4 v[188:191], v14, s[20:23], s53 offen offset:3072
    s_add_u32 s53, s53, 4096
    s_waitcnt vmcnt(28)
    s_barrier
    s_add_u32 m0, s56, 114688
    s_nop 0
    buffer_load_dwordx4 v14, s[20:23], s59 offen offset:0 lds
    buffer_load_dwordx4 v14, s[20:23], s59 offen offset:1024 lds
    buffer_load_dwordx4 v14, s[20:23], s59 offen offset:2048 lds
    buffer_load_dwordx4 v14, s[20:23], s59 offen offset:3072 lds
    s_add_u32 s59, s59, 4096
    s_add_u32 m0, s56, 118784
    s_nop 0
    buffer_load_dwordx4 v14, s[20:23], s59 offen offset:0 lds
    buffer_load_dwordx4 v14, s[20:23], s59 offen offset:1024 lds
    buffer_load_dwordx4 v14, s[20:23], s59 offen offset:2048 lds
    buffer_load_dwordx4 v14, s[20:23], s59 offen offset:3072 lds
    s_add_u32 s59, s59, 4096
    s_add_u32 m0, s56, 122880
    s_nop 0
    buffer_load_dwordx4 v14, s[20:23], s59 offen offset:0 lds
    buffer_load_dwordx4 v14, s[20:23], s59 offen offset:1024 lds
    buffer_load_dwordx4 v14, s[20:23], s59 offen offset:2048 lds
    buffer_load_dwordx4 v14, s[20:23], s59 offen offset:3072 lds
    s_add_u32 s59, s59, 4096
    s_lshl_b32 s49, s41, 1
    s_add_u32 s48, s63, s49
    v_add_u32 v8, 57344, v14
    v_add_u32 v9, 114688, v14
    v_add_u32 v10, 172032, v14
    v_and_b32 v4, 3, v1
    v_lshlrev_b32 v4, 5, v4
    v_and_b32 v5, 4, v1
    v_lshl_add_u32 v4, v5, 2, v4
    v_bfe_u32 v5, v1, 3, 1
    v_lshl_add_u32 v6, v3, 2, v5
    v_lshl_add_u32 v6, v6, 10, v4
    s_lshl_b32 s50, s48, 16
    s_lshr_b32 s51, s40, 1
    s_lshl_b32 s52, s51, 14
    s_add_u32 s50, s50, s52
    s_and_b32 s52, s40, 1
    s_lshl_b32 s53, s52, 11
    s_add_u32 s50, s50, s53
    s_lshl_b32 s53, s62, 7
    s_add_u32 s50, s50, s53
    s_add_u32 s50, s50, 6406144
    v_lshrrev_b32 v15, 1, v3
    v_lshlrev_b32 v15, 18, v15
    v_and_b32 v23, 1, v3
    v_lshl_add_u32 v15, v23, 17, v15
    v_lshl_add_u32 v15, v5, 15, v15
    v_add_u32 v15, v15, v4
    s_lshr_b32 s54, s41, 3
    s_lshl_b32 s54, s54, 20
    s_and_b32 s55, s51, 1
    s_lshl_b32 s55, s55, 19
    s_add_u32 s54, s54, s55
    s_lshl_b32 s55, s52, 16
    s_add_u32 s54, s54, s55
    s_and_b32 s55, s41, 7
    s_lshl_b32 s55, s55, 12
    s_add_u32 s54, s54, s55
    s_lshl_b32 s55, s63, 11
    s_add_u32 s54, s54, s55
    s_lshr_b32 s55, s51, 1
    s_lshl_b32 s55, s55, 10
    s_add_u32 s54, s54, s55
    s_add_u32 s54, s54, s53
    v_and_b32 v4, 3, v1
    v_lshl_add_u32 v4, v4, 2, v5
    v_mul_u32_u24 v4, 272, v4
    v_lshl_add_u32 v4, v3, 6, v4
    v_and_b32 v5, 4, v1
    v_lshl_add_u32 v4, v5, 3, v4
    s_mul_i32 s55, s51, 4352
    s_mul_i32 s53, s52, 544
    s_add_u32 s55, s55, s53
    v_add_u32 v4, s55, v4
    v_add_u32 v5, 69632, v4
    s_mul_i32 s55, s40, 17408
    s_mul_i32 s49, s48, 224
    s_mul_i32 s53, s42, 7
    s_add_u32 s49, s49, s53
    s_lshl_b32 s49, s49, 10
    s_add_u32 s49, s49, 12435456
    s_barrier
    s_add_u32 m0, s57, 0
    s_nop 0
    buffer_load_dwordx4 v14, s[20:23], s59 offen offset:0 lds
    buffer_load_dwordx4 v14, s[20:23], s59 offen offset:1024 lds
    buffer_load_dwordx4 v14, s[20:23], s59 offen offset:2048 lds
    buffer_load_dwordx4 v14, s[20:23], s59 offen offset:3072 lds
    s_add_u32 s59, s59, 4096
    s_add_u32 m0, s57, 4096
    s_nop 0
    buffer_load_dwordx4 v14, s[20:23], s59 offen offset:0 lds
    buffer_load_dwordx4 v14, s[20:23], s59 offen offset:1024 lds
    buffer_load_dwordx4 v14, s[20:23], s59 offen offset:2048 lds
    buffer_load_dwordx4 v14, s[20:23], s59 offen offset:3072 lds
    s_add_u32 s59, s59, 4096
    s_add_u32 m0, s57, 8192
    s_nop 0
    buffer_load_dwordx4 v14, s[20:23], s59 offen offset:0 lds
    buffer_load_dwordx4 v14, s[20:23], s59 offen offset:1024 lds
    buffer_load_dwordx4 v14, s[20:23], s59 offen offset:2048 lds
    buffer_load_dwordx4 v14, s[20:23], s59 offen offset:3072 lds
    s_add_u32 s59, s59, 4096
    s_add_u32 m0, s57, 12288
    s_nop 0
    buffer_load_dwordx4 v14, s[20:23], s59 offen offset:0 lds
    buffer_load_dwordx4 v14, s[20:23], s59 offen offset:1024 lds
    buffer_load_dwordx4 v14, s[20:23], s59 offen offset:2048 lds
    buffer_load_dwordx4 v14, s[20:23], s59 offen offset:3072 lds
    s_add_u32 s59, s59, 4096
    s_lshl_b32 s44, s41, 9
    s_add_u32 s44, s44, 21610496
    s_lshr_b32 s45, s43, 2
    s_lshl_b32 s45, s45, 7
    s_add_u32 s45, s45, s44
    s_and_b32 s46, s43, 3
    s_lshl_b32 s46, s46, 2
    s_add_u32 s45, s45, s46
    s_lshl_b32 s46, s40, 7
    s_add_u32 s44, s44, s46
    s_lshl_b32 s46, s41, 10
    s_add_u32 s46, s46, 21618688
    s_lshr_b32 s47, s43, 1
    s_lshl_b32 s47, s47, 7
    s_add_u32 s47, s47, s46
    s_and_b32 s53, s43, 1
    s_lshl_b32 s53, s53, 2
    s_add_u32 s47, s47, s53
    s_xor_b32 s53, s40, 4
    s_lshl_b32 s53, s53, 7
    s_add_u32 s46, s46, s53
    s_waitcnt vmcnt(0)
    s_barrier
    v_and_b32 v242, 1, v1
    v_lshlrev_b32 v242, 2, v242
    s_mov_b32 s58, 200000
    buffer_load_dword v243, v242, s[20:23], s46 offen sc1
    buffer_load_dword v244, v242, s[20:23], s46 offen sc1
LF2L_poll:
    s_waitcnt vmcnt(1)
    v_cmp_eq_u32 vcc, 1, v243
    buffer_load_dword v243, v242, s[20:23], s46 offen sc1
    s_nop 2
    s_cmp_eq_u64 vcc, exec
    s_cbranch_scc1 LF2L_join
    s_waitcnt vmcnt(1)
    v_cmp_eq_u32 vcc, 1, v244
    buffer_load_dword v244, v242, s[20:23], s46 offen sc1
    s_nop 2
    s_cmp_eq_u64 vcc, exec
    s_cbranch_scc1 LF2L_join
    s_sub_u32 s58, s58, 1
    s_cmp_lg_u32 s58, 0
    s_cbranch_scc1 LF2L_poll
LF2L_join:
    s_nop 1
    buffer_load_dwordx4 v[16:19], v14, s[20:23], s49 offen sc1
    buffer_load_dwordx4 v[20:23], v8, s[20:23], s49 offen sc1
    buffer_load_dwordx4 v[24:27], v9, s[20:23], s49 offen sc1
    buffer_load_dwordx4 v[28:31], v10, s[20:23], s49 offen sc1
    s_add_u32 s49, s49, 1024
    buffer_load_dwordx4 v[32:35], v14, s[20:23], s49 offen sc1
    buffer_load_dwordx4 v[36:39], v8, s[20:23], s49 offen sc1
    buffer_load_dwordx4 v[40:43], v9, s[20:23], s49 offen sc1
    buffer_load_dwordx4 v[44:47], v10, s[20:23], s49 offen sc1
    s_add_u32 s49, s49, 1024
    buffer_load_dwordx4 v[48:51], v14, s[20:23], s49 offen sc1
    buffer_load_dwordx4 v[52:55], v8, s[20:23], s49 offen sc1
    buffer_load_dwordx4 v[56:59], v9, s[20:23], s49 offen sc1
    buffer_load_dwordx4 v[60:63], v10, s[20:23], s49 offen sc1
    s_add_u32 s49, s49, 1024
    s_mov_b32 m0, s55
    s_waitcnt vmcnt(11)
    v_mfma_f32_16x16x32_bf16 v[192:195], v[16:19], v[80:83], 0
    v_mfma_f32_16x16x32_bf16 v[196:199], v[16:19], v[84:87], 0
    v_mfma_f32_16x16x32_bf16 v[200:203], v[16:19], v[88:91], 0
    v_mfma_f32_16x16x32_bf16 v[204:207], v[16:19], v[92:95], 0
    buffer_load_dwordx4 v[64:67], v14, s[20:23], s49 offen sc1
    s_waitcnt vmcnt(11)
    v_mfma_f32_16x16x32_bf16 v[208:211], v[20:23], v[80:83], 0
    v_mfma_f32_16x16x32_bf16 v[212:215], v[20:23], v[84:87], 0
    v_mfma_f32_16x16x32_bf16 v[216:219], v[20:23], v[88:91], 0
    v_mfma_f32_16x16x32_bf16 v[220:223], v[20:23], v[92:95], 0
    buffer_load_dwordx4 v[68:71], v8, s[20:23], s49 offen sc1
    s_waitcnt vmcnt(11)
    v_mfma_f32_16x16x32_bf16 v[224:227], v[24:27], v[80:83], 0
    v_mfma_f32_16x16x32_bf16 v[228:231], v[24:27], v[84:87], 0
    v_mfma_f32_16x16x32_bf16 v[232:235], v[24:27], v[88:91], 0
    v_mfma_f32_16x16x32_bf16 v[236:239], v[24:27], v[92:95], 0
    buffer_load_dwordx4 v[72:75], v9, s[20:23], s49 offen sc1
    s_waitcnt vmcnt(11)
    v_mfma_f32_16x16x32_bf16 v[240:243], v[28:31], v[80:83], 0
    v_mfma_f32_16x16x32_bf16 v[244:247], v[28:31], v[84:87], 0
    v_mfma_f32_16x16x32_bf16 v[248:251], v[28:31], v[88:91], 0
    v_mfma_f32_16x16x32_bf16 v[252:255], v[28:31], v[92:95], 0
    buffer_load_dwordx4 v[76:79], v10, s[20:23], s49 offen sc1
    s_add_u32 s49, s49, 1024
    s_waitcnt vmcnt(11)
    v_mfma_f32_16x16x32_bf16 v[192:195], v[32:35], v[96:99], v[192:195]
    v_mfma_f32_16x16x32_bf16 v[196:199], v[32:35], v[100:103], v[196:199]
    v_mfma_f32_16x16x32_bf16 v[200:203], v[32:35], v[104:107], v[200:203]
    v_mfma_f32_16x16x32_bf16 v[204:207], v[32:35], v[108:111], v[204:207]
    buffer_load_dwordx4 v[16:19], v14, s[20:23], s49 offen sc1
    s_waitcnt vmcnt(11)
    v_mfma_f32_16x16x32_bf16 v[208:211], v[36:39], v[96:99], v[208:211]
    v_mfma_f32_16x16x32_bf16 v[212:215], v[36:39], v[100:103], v[212:215]
    v_mfma_f32_16x16x32_bf16 v[216:219], v[36:39], v[104:107], v[216:219]
    v_mfma_f32_16x16x32_bf16 v[220:223], v[36:39], v[108:111], v[220:223]
    buffer_load_dwordx4 v[20:23], v8, s[20:23], s49 offen sc1
    s_waitcnt vmcnt(11)
    v_mfma_f32_16x16x32_bf16 v[224:227], v[40:43], v[96:99], v[224:227]
    v_mfma_f32_16x16x32_bf16 v[228:231], v[40:43], v[100:103], v[228:231]
    v_mfma_f32_16x16x32_bf16 v[232:235], v[40:43], v[104:107], v[232:235]
    v_mfma_f32_16x16x32_bf16 v[236:239], v[40:43], v[108:111], v[236:239]
    buffer_load_dwordx4 v[24:27], v9, s[20:23], s49 offen sc1
    s_waitcnt vmcnt(11)
    v_mfma_f32_16x16x32_bf16 v[240:243], v[44:47], v[96:99], v[240:243]
    v_mfma_f32_16x16x32_bf16 v[244:247], v[44:47], v[100:103], v[244:247]
    v_mfma_f32_16x16x32_bf16 v[248:251], v[44:47], v[104:107], v[248:251]
    v_mfma_f32_16x16x32_bf16 v[252:255], v[44:47], v[108:111], v[252:255]
    buffer_load_dwordx4 v[28:31], v10, s[20:23], s49 offen sc1
    s_add_u32 s49, s49, 1024
    s_barrier
    s_waitcnt vmcnt(11)
    v_mfma_f32_16x16x32_bf16 v[192:195], v[48:51], v[112:115], v[192:195]
    v_mfma_f32_16x16x32_bf16 v[196:199], v[48:51], v[116:119], v[196:199]
    v_mfma_f32_16x16x32_bf16 v[200:203], v[48:51], v[120:123], v[200:203]
    v_mfma_f32_16x16x32_bf16 v[204:207], v[48:51], v[124:127], v[204:207]
    buffer_load_dwordx4 v[32:35], v14, s[20:23], s49 offen sc1
    s_waitcnt vmcnt(11)
    v_mfma_f32_16x16x32_bf16 v[208:211], v[52:55], v[112:115], v[208:211]
    v_mfma_f32_16x16x32_bf16 v[212:215], v[52:55], v[116:119], v[212:215]
    v_mfma_f32_16x16x32_bf16 v[216:219], v[52:55], v[120:123], v[216:219]
    v_mfma_f32_16x16x32_bf16 v[220:223], v[52:55], v[124:127], v[220:223]
    buffer_load_dwordx4 v[36:39], v8, s[20:23], s49 offen sc1
    s_waitcnt vmcnt(11)
    v_mfma_f32_16x16x32_bf16 v[224:227], v[56:59], v[112:115], v[224:227]
    v_mfma_f32_16x16x32_bf16 v[228:231], v[56:59], v[116:119], v[228:231]
    v_mfma_f32_16x16x32_bf16 v[232:235], v[56:59], v[120:123], v[232:235]
    v_mfma_f32_16x16x32_bf16 v[236:239], v[56:59], v[124:127], v[236:239]
    buffer_load_dwordx4 v[40:43], v9, s[20:23], s49 offen sc1
    s_waitcnt vmcnt(11)
    v_mfma_f32_16x16x32_bf16 v[240:243], v[60:63], v[112:115], v[240:243]
    v_mfma_f32_16x16x32_bf16 v[244:247], v[60:63], v[116:119], v[244:247]
    v_mfma_f32_16x16x32_bf16 v[248:251], v[60:63], v[120:123], v[248:251]
    v_mfma_f32_16x16x32_bf16 v[252:255], v[60:63], v[124:127], v[252:255]
    buffer_load_dwordx4 v[44:47], v10, s[20:23], s49 offen sc1
    s_add_u32 s49, s49, 1024
    s_waitcnt vmcnt(11)
    v_mfma_f32_16x16x32_bf16 v[192:195], v[64:67], v[128:131], v[192:195]
    v_mfma_f32_16x16x32_bf16 v[196:199], v[64:67], v[132:135], v[196:199]
    v_mfma_f32_16x16x32_bf16 v[200:203], v[64:67], v[136:139], v[200:203]
    v_mfma_f32_16x16x32_bf16 v[204:207], v[64:67], v[140:143], v[204:207]
    v_lshrrev_b32 v13, 1, v14
    buffer_load_dwordx2 v[48:49], v13, s[20:23], s49 offen sc1
    buffer_load_dwordx2 v[50:51], v13, s[20:23], s49 offen offset:512 sc1
    s_waitcnt vmcnt(12)
    v_mfma_f32_16x16x32_bf16 v[208:211], v[68:71], v[128:131], v[208:211]
    v_mfma_f32_16x16x32_bf16 v[212:215], v[68:71], v[132:135], v[212:215]
    v_mfma_f32_16x16x32_bf16 v[216:219], v[68:71], v[136:139], v[216:219]
    v_mfma_f32_16x16x32_bf16 v[220:223], v[68:71], v[140:143], v[220:223]
    v_add_u32 v13, 57344, v13
    buffer_load_dwordx2 v[52:53], v13, s[20:23], s49 offen sc1
    buffer_load_dwordx2 v[54:55], v13, s[20:23], s49 offen offset:512 sc1
    s_waitcnt vmcnt(13)
    v_mfma_f32_16x16x32_bf16 v[224:227], v[72:75], v[128:131], v[224:227]
    v_mfma_f32_16x16x32_bf16 v[228:231], v[72:75], v[132:135], v[228:231]
    v_mfma_f32_16x16x32_bf16 v[232:235], v[72:75], v[136:139], v[232:235]
    v_mfma_f32_16x16x32_bf16 v[236:239], v[72:75], v[140:143], v[236:239]
    v_add_u32 v13, 57344, v13
    buffer_load_dwordx2 v[56:57], v13, s[20:23], s49 offen sc1
    buffer_load_dwordx2 v[58:59], v13, s[20:23], s49 offen offset:512 sc1
    s_waitcnt vmcnt(14)
    v_mfma_f32_16x16x32_bf16 v[240:243], v[76:79], v[128:131], v[240:243]
    v_mfma_f32_16x16x32_bf16 v[244:247], v[76:79], v[132:135], v[244:247]
    v_mfma_f32_16x16x32_bf16 v[248:251], v[76:79], v[136:139], v[248:251]
    v_mfma_f32_16x16x32_bf16 v[252:255], v[76:79], v[140:143], v[252:255]
    v_add_u32 v13, 57344, v13
    buffer_load_dwordx2 v[60:61], v13, s[20:23], s49 offen sc1
    buffer_load_dwordx2 v[62:63], v13, s[20:23], s49 offen offset:512 sc1
    buffer_load_dwordx4 v[64:67], v6, s[20:23], s50 offen sc1
    s_waitcnt vmcnt(16)
    v_mfma_f32_16x16x32_bf16 v[192:195], v[16:19], v[144:147], v[192:195]
    v_mfma_f32_16x16x32_bf16 v[196:199], v[16:19], v[148:151], v[196:199]
    v_mfma_f32_16x16x32_bf16 v[200:203], v[16:19], v[152:155], v[200:203]
    v_mfma_f32_16x16x32_bf16 v[204:207], v[16:19], v[156:159], v[204:207]
    s_waitcnt vmcnt(15)
    v_mfma_f32_16x16x32_bf16 v[208:211], v[20:23], v[144:147], v[208:211]
    v_mfma_f32_16x16x32_bf16 v[212:215], v[20:23], v[148:151], v[212:215]
    v_mfma_f32_16x16x32_bf16 v[216:219], v[20:23], v[152:155], v[216:219]
    v_mfma_f32_16x16x32_bf16 v[220:223], v[20:23], v[156:159], v[220:223]
    s_waitcnt vmcnt(14)
    v_mfma_f32_16x16x32_bf16 v[224:227], v[24:27], v[144:147], v[224:227]
    v_mfma_f32_16x16x32_bf16 v[228:231], v[24:27], v[148:151], v[228:231]
    v_mfma_f32_16x16x32_bf16 v[232:235], v[24:27], v[152:155], v[232:235]
    v_mfma_f32_16x16x32_bf16 v[236:239], v[24:27], v[156:159], v[236:239]
    s_waitcnt vmcnt(13)
    v_mfma_f32_16x16x32_bf16 v[240:243], v[28:31], v[144:147], v[240:243]
    v_mfma_f32_16x16x32_bf16 v[244:247], v[28:31], v[148:151], v[244:247]
    v_mfma_f32_16x16x32_bf16 v[248:251], v[28:31], v[152:155], v[248:251]
    v_mfma_f32_16x16x32_bf16 v[252:255], v[28:31], v[156:159], v[252:255]
    s_waitcnt vmcnt(12)
    v_mfma_f32_16x16x32_bf16 v[192:195], v[32:35], v[160:163], v[192:195]
    v_mfma_f32_16x16x32_bf16 v[196:199], v[32:35], v[164:167], v[196:199]
    v_mfma_f32_16x16x32_bf16 v[200:203], v[32:35], v[168:171], v[200:203]
    v_mfma_f32_16x16x32_bf16 v[204:207], v[32:35], v[172:175], v[204:207]
    s_waitcnt vmcnt(11)
    v_mfma_f32_16x16x32_bf16 v[208:211], v[36:39], v[160:163], v[208:211]
    v_mfma_f32_16x16x32_bf16 v[212:215], v[36:39], v[164:167], v[212:215]
    v_mfma_f32_16x16x32_bf16 v[216:219], v[36:39], v[168:171], v[216:219]
    v_mfma_f32_16x16x32_bf16 v[220:223], v[36:39], v[172:175], v[220:223]
    s_waitcnt vmcnt(10)
    v_mfma_f32_16x16x32_bf16 v[224:227], v[40:43], v[160:163], v[224:227]
    v_mfma_f32_16x16x32_bf16 v[228:231], v[40:43], v[164:167], v[228:231]
    v_mfma_f32_16x16x32_bf16 v[232:235], v[40:43], v[168:171], v[232:235]
    v_mfma_f32_16x16x32_bf16 v[236:239], v[40:43], v[172:175], v[236:239]
    s_waitcnt vmcnt(9)
    v_mfma_f32_16x16x32_bf16 v[240:243], v[44:47], v[160:163], v[240:243]
    v_mfma_f32_16x16x32_bf16 v[244:247], v[44:47], v[164:167], v[244:247]
    v_mfma_f32_16x16x32_bf16 v[248:251], v[44:47], v[168:171], v[248:251]
    v_mfma_f32_16x16x32_bf16 v[252:255], v[44:47], v[172:175], v[252:255]
    s_waitcnt vmcnt(7)
    v_mfma_f32_16x16x32_bf16 v[192:195], v[48:51], v[176:179], v[192:195]
    v_mfma_f32_16x16x32_bf16 v[196:199], v[48:51], v[180:183], v[196:199]
    v_mfma_f32_16x16x32_bf16 v[200:203], v[48:51], v[184:187], v[200:203]
    v_mfma_f32_16x16x32_bf16 v[204:207], v[48:51], v[188:191], v[204:207]
    s_waitcnt vmcnt(5)
    v_mfma_f32_16x16x32_bf16 v[208:211], v[52:55], v[176:179], v[208:211]
    v_mfma_f32_16x16x32_bf16 v[212:215], v[52:55], v[180:183], v[212:215]
    v_mfma_f32_16x16x32_bf16 v[216:219], v[52:55], v[184:187], v[216:219]
    v_mfma_f32_16x16x32_bf16 v[220:223], v[52:55], v[188:191], v[220:223]
    s_waitcnt vmcnt(3)
    v_mfma_f32_16x16x32_bf16 v[224:227], v[56:59], v[176:179], v[224:227]
    v_mfma_f32_16x16x32_bf16 v[228:231], v[56:59], v[180:183], v[228:231]
    v_mfma_f32_16x16x32_bf16 v[232:235], v[56:59], v[184:187], v[232:235]
    v_mfma_f32_16x16x32_bf16 v[236:239], v[56:59], v[188:191], v[236:239]
    s_waitcnt vmcnt(1)
    v_mfma_f32_16x16x32_bf16 v[240:243], v[60:63], v[176:179], v[240:243]
    v_mfma_f32_16x16x32_bf16 v[244:247], v[60:63], v[180:183], v[244:247]
    v_mfma_f32_16x16x32_bf16 v[248:251], v[60:63], v[184:187], v[248:251]
    v_mfma_f32_16x16x32_bf16 v[252:255], v[60:63], v[188:191], v[252:255]
LF_red:
    s_nop 7
    ds_write_addtid_b32 v192 offset:0
    ds_write_addtid_b32 v193 offset:272
    ds_write_addtid_b32 v194 offset:544
    ds_write_addtid_b32 v195 offset:816
    ds_write_addtid_b32 v196 offset:1088
    ds_write_addtid_b32 v197 offset:1360
    ds_write_addtid_b32 v198 offset:1632
    ds_write_addtid_b32 v199 offset:1904
    ds_write_addtid_b32 v200 offset:2176
    ds_write_addtid_b32 v201 offset:2448
    ds_write_addtid_b32 v202 offset:2720
    ds_write_addtid_b32 v203 offset:2992
    ds_write_addtid_b32 v204 offset:3264
    ds_write_addtid_b32 v205 offset:3536
    ds_write_addtid_b32 v206 offset:3808
    ds_write_addtid_b32 v207 offset:4080
    ds_write_addtid_b32 v208 offset:4352
    ds_write_addtid_b32 v209 offset:4624
    ds_write_addtid_b32 v210 offset:4896
    ds_write_addtid_b32 v211 offset:5168
    ds_write_addtid_b32 v212 offset:5440
    ds_write_addtid_b32 v213 offset:5712
    ds_write_addtid_b32 v214 offset:5984
    ds_write_addtid_b32 v215 offset:6256
    ds_write_addtid_b32 v216 offset:6528
    ds_write_addtid_b32 v217 offset:6800
    ds_write_addtid_b32 v218 offset:7072
    ds_write_addtid_b32 v219 offset:7344
    ds_write_addtid_b32 v220 offset:7616
    ds_write_addtid_b32 v221 offset:7888
    ds_write_addtid_b32 v222 offset:8160
    ds_write_addtid_b32 v223 offset:8432
    ds_write_addtid_b32 v224 offset:8704
    ds_write_addtid_b32 v225 offset:8976
    ds_write_addtid_b32 v226 offset:9248
    ds_write_addtid_b32 v227 offset:9520
    ds_write_addtid_b32 v228 offset:9792
    ds_write_addtid_b32 v229 offset:10064
    ds_write_addtid_b32 v230 offset:10336
    ds_write_addtid_b32 v231 offset:10608
    ds_write_addtid_b32 v232 offset:10880
    ds_write_addtid_b32 v233 offset:11152
    ds_write_addtid_b32 v234 offset:11424
    ds_write_addtid_b32 v235 offset:11696
    ds_write_addtid_b32 v236 offset:11968
    ds_write_addtid_b32 v237 offset:12240
    ds_write_addtid_b32 v238 offset:12512
    ds_write_addtid_b32 v239 offset:12784
    ds_write_addtid_b32 v240 offset:13056
    ds_write_addtid_b32 v241 offset:13328
    ds_write_addtid_b32 v242 offset:13600
    ds_write_addtid_b32 v243 offset:13872
    ds_write_addtid_b32 v244 offset:14144
    ds_write_addtid_b32 v245 offset:14416
    ds_write_addtid_b32 v246 offset:14688
    ds_write_addtid_b32 v247 offset:14960
    ds_write_addtid_b32 v248 offset:15232
    ds_write_addtid_b32 v249 offset:15504
    ds_write_addtid_b32 v250 offset:15776
    ds_write_addtid_b32 v251 offset:16048
    ds_write_addtid_b32 v252 offset:16320
    ds_write_addtid_b32 v253 offset:16592
    ds_write_addtid_b32 v254 offset:16864
    ds_write_addtid_b32 v255 offset:17136
    s_waitcnt vmcnt(0)
    v_lshlrev_b32 v68, 16, v64
    v_and_b32 v69, 0xffff0000, v64
    v_lshlrev_b32 v70, 16, v65
    v_and_b32 v71, 0xffff0000, v65
    v_lshlrev_b32 v72, 16, v66
    v_and_b32 v73, 0xffff0000, v66
    v_lshlrev_b32 v74, 16, v67
    v_and_b32 v75, 0xffff0000, v67
    s_waitcnt lgkmcnt(0)
    s_barrier
    ds_read_b128 v[80:83], v4 offset:0
    ds_read_b128 v[84:87], v4 offset:16
    ds_read_b128 v[88:91], v4 offset:17408
    ds_read_b128 v[92:95], v4 offset:17424
    ds_read_b128 v[96:99], v4 offset:34816
    ds_read_b128 v[100:103], v4 offset:34832
    ds_read_b128 v[104:107], v4 offset:52224
    ds_read_b128 v[108:111], v4 offset:52240
    ds_read_b128 v[112:115], v5 offset:0
    ds_read_b128 v[116:119], v5 offset:16
    ds_read_b128 v[120:123], v5 offset:17408
    ds_read_b128 v[124:127], v5 offset:17424
    ds_read_b128 v[128:131], v5 offset:34816
    ds_read_b128 v[132:135], v5 offset:34832
    ds_read_b128 v[136:139], v5 offset:52224
    ds_read_b128 v[140:143], v5 offset:52240
    s_waitcnt lgkmcnt(13)
    v_pk_add_f32 v[80:81], v[80:81], v[88:89]
    v_pk_add_f32 v[82:83], v[82:83], v[90:91]
    s_waitcnt lgkmcnt(12)
    v_pk_add_f32 v[84:85], v[84:85], v[92:93]
    v_pk_add_f32 v[86:87], v[86:87], v[94:95]
    s_waitcnt lgkmcnt(9)
    v_pk_add_f32 v[96:97], v[96:97], v[104:105]
    v_pk_add_f32 v[98:99], v[98:99], v[106:107]
    s_waitcnt lgkmcnt(8)
    v_pk_add_f32 v[100:101], v[100:101], v[108:109]
    v_pk_add_f32 v[102:103], v[102:103], v[110:111]
    s_waitcnt lgkmcnt(5)
    v_pk_add_f32 v[112:113], v[112:113], v[120:121]
    v_pk_add_f32 v[114:115], v[114:115], v[122:123]
    s_waitcnt lgkmcnt(4)
    v_pk_add_f32 v[116:117], v[116:117], v[124:125]
    v_pk_add_f32 v[118:119], v[118:119], v[126:127]
    s_waitcnt lgkmcnt(1)
    v_pk_add_f32 v[128:129], v[128:129], v[136:137]
    v_pk_add_f32 v[130:131], v[130:131], v[138:139]
    s_waitcnt lgkmcnt(0)
    v_pk_add_f32 v[132:133], v[132:133], v[140:141]
    v_pk_add_f32 v[134:135], v[134:135], v[142:143]
    v_pk_add_f32 v[80:81], v[80:81], v[96:97]
    v_pk_add_f32 v[82:83], v[82:83], v[98:99]
    v_pk_add_f32 v[84:85], v[84:85], v[100:101]
    v_pk_add_f32 v[86:87], v[86:87], v[102:103]
    v_pk_add_f32 v[112:113], v[112:113], v[128:129]
    v_pk_add_f32 v[114:115], v[114:115], v[130:131]
    v_pk_add_f32 v[116:117], v[116:117], v[132:133]
    v_pk_add_f32 v[118:119], v[118:119], v[134:135]
    v_pk_add_f32 v[80:81], v[80:81], v[112:113]
    v_pk_add_f32 v[82:83], v[82:83], v[114:115]
    v_pk_add_f32 v[84:85], v[84:85], v[116:117]
    v_pk_add_f32 v[86:87], v[86:87], v[118:119]
    v_cvt_pk_bf16_f32 v80, v80, v81
    v_cvt_pk_bf16_f32 v82, v82, v83
    v_cvt_pk_bf16_f32 v84, v84, v85
    v_cvt_pk_bf16_f32 v86, v86, v87
    v_and_b32 v81, 0xffff0000, v80
    v_lshlrev_b32 v80, 16, v80
    v_and_b32 v83, 0xffff0000, v82
    v_lshlrev_b32 v82, 16, v82
    v_and_b32 v85, 0xffff0000, v84
    v_lshlrev_b32 v84, 16, v84
    v_and_b32 v87, 0xffff0000, v86
    v_lshlrev_b32 v86, 16, v86
    v_pk_add_f32 v[80:81], v[80:81], v[68:69]
    v_pk_add_f32 v[82:83], v[82:83], v[70:71]
    v_pk_add_f32 v[84:85], v[84:85], v[72:73]
    v_pk_add_f32 v[86:87], v[86:87], v[74:75]
    v_cvt_pk_bf16_f32 v96, v80, v81
    v_cvt_pk_bf16_f32 v97, v82, v83
    v_cvt_pk_bf16_f32 v98, v84, v85
    v_cvt_pk_bf16_f32 v99, v86, v87
    buffer_store_dwordx4 v[96:99], v15, s[28:31], s54 offen sc1
LF_end:
    s_endpgm
LF_codeend:

.section .rodata,"a"
.p2align 6
.amdhsa_kernel kf_kernel
  .amdhsa_next_free_vgpr 256
  .amdhsa_next_free_sgpr 95
  .amdhsa_accum_offset 256
  .amdhsa_group_segment_fixed_size 0
  .amdhsa_kernarg_size 72
  .amdhsa_user_sgpr_count 2
  .amdhsa_user_sgpr_kernarg_segment_ptr 1
  .amdhsa_system_sgpr_workgroup_id_x 1
.end_amdhsa_kernel
```
